```python
import torch

def _softmax(x, axis=-1):
    return torch.softmax(x, dim=axis)
def _gelu(x):
    return torch.nn.functional.gelu(x, approximate="tanh")
def _silu(x):
    return torch.nn.functional.silu(x)
def _sigmoid(x):
    return torch.sigmoid(x)
def _layernorm(x, axis=-1, eps=1e-5):
    m = x.mean(dim=axis, keepdim=True)
    v = x.var(dim=axis, keepdim=True, unbiased=False)
    return (x - m) / torch.sqrt(v + eps)
def _scatter_add(tgt, idx, src, axis=0):
    return tgt.clone().index_add_(axis, idx, src)
def _segment_sum(src, seg, n):
    out = torch.zeros((n,) + src.shape[1:], dtype=src.dtype)
    return out.index_add_(0, seg, src)
def _pad(x, pw):
    flat = tuple(v for pair in reversed(pw) for v in pair)
    return torch.nn.functional.pad(x, flat)

kernel_name = 'parallel_sum__compressed_kv_cla__geglu_ffn__decode'

def setup_inputs():

    _w = (lambda a: (lambda t: t.to(torch.bfloat16) if t.is_floating_point() else t)(torch.as_tensor(a)))
    def _A_setup():
        B, H, Sq, Sk, D, M = 8, 32, 1, 4096, 128, 512
        Dc = 4 * D
        return {
            "x": _w((lambda *s: torch.randn(*s, dtype=torch.bfloat16) * 0.05)(B, Sq, M)),
            "c_kv": _w((lambda *s: torch.randn(*s, dtype=torch.bfloat16) * 1.6)(B, Sk, Dc)),
            "w_q": _w((lambda *s: torch.randn(*s, dtype=torch.bfloat16) * 3.2)(M, H, D) * (M ** -0.5)),
            "w_uk": _w((lambda *s: torch.randn(*s, dtype=torch.bfloat16) * 3.2)(Dc, H, D) * (Dc ** -0.5)),
            "w_uv": _w((lambda *s: torch.randn(*s, dtype=torch.bfloat16) * 1.6)(Dc, H, D) * (Dc ** -0.5)),
            "w_o": _w((lambda *s: torch.randn(*s, dtype=torch.bfloat16) * 1.6)(H, D, M) * ((H * D) ** -0.5)),
        }
    _A_in = _A_setup()

    def _B_setup():
        B, S, D, F = 8, 1, 512, 1376
        return {
            "x": _w((lambda *s: torch.randn(*s, dtype=torch.bfloat16) * 0.05)(B, S, D)),
            "w_gate": _w((lambda *s: torch.randn(*s, dtype=torch.bfloat16) * 0.1)(D, F)),
            "w_up": _w((lambda *s: torch.randn(*s, dtype=torch.bfloat16) * 0.1)(D, F)),
            "w_down": _w((lambda *s: torch.randn(*s, dtype=torch.bfloat16) * 0.1)(F, D)),
        }
    _B_in = _B_setup()

    return {
        "A_x": _A_in["x"],
        "A_c_kv": _A_in["c_kv"],
        "A_w_q": _A_in["w_q"],
        "A_w_uk": _A_in["w_uk"],
        "A_w_uv": _A_in["w_uv"],
        "A_w_o": _A_in["w_o"],
        "B_x": _B_in["x"],
        "B_w_gate": _B_in["w_gate"],
        "B_w_up": _B_in["w_up"],
        "B_w_down": _B_in["w_down"],
    }

def reference(A_x, A_c_kv, A_w_q, A_w_uk, A_w_uv, A_w_o, B_x, B_w_gate, B_w_up, B_w_down):
    def _A_ref(x, c_kv, w_q, w_uk, w_uv, w_o):
        B, Sq, M = x.shape[0], x.shape[1], x.shape[2]
        Sk = c_kv.shape[1]
        H, D = w_q.shape[1], w_q.shape[2]
        q = torch.einsum("bqm,mhd->bhqd", x, w_q)
        k = torch.einsum("bkc,chd->bhkd", c_kv, w_uk)
        v = torch.einsum("bkc,chd->bhkd", c_kv, w_uv)
        scores = torch.einsum("bhqd,bhkd->bhqk", q, k) * (D ** -0.5)
        off = Sk - Sq
        qi = torch.arange(Sq)[:, None]
        kj = torch.arange(Sk)[None, :]
        cmask = kj <= (qi + off)
        scores = torch.where(cmask[None, None], scores, -1e9)
        p = _softmax(scores, axis=-1)
        ctx = torch.einsum("bhqk,bhkd->bhqd", p, v)
        return torch.einsum("bhqd,hdm->bqm", ctx, w_o)

    def _B_ref(x, w_gate, w_up, w_down):
        return (_gelu(x @ w_gate) * (x @ w_up)) @ w_down

    x = A_x
    xn = _layernorm(x, axis=-1)
    return x + _A_ref(xn, A_c_kv, A_w_q, A_w_uk, A_w_uv, A_w_o) + _B_ref(xn, B_w_gate, B_w_up, B_w_down)
```

```asm
; @launch kernel=k1_kernel grid=(256,1,1) block=(512,1,1) lds=160256
; @launch kernel=k2_kernel grid=(256,1,1) block=(512,1,1) lds=163840
; @launch kernel=k3_kernel grid=(256,1,1) block=(512,1,1) lds=106496
; @launch kernel=k4_kernel grid=(64,1,1) block=(256,1,1) lds=4096
.amdgcn_target "amdgcn-amd-amdhsa--gfx950"
.text
.globl k1_kernel
.p2align 8
.type k1_kernel,@function
k1_kernel:
    s_cmp_ge_u32 s2, 256
    s_cbranch_scc1 K1_END
    s_load_dwordx4 s[4:7], s[0:1], 0
    s_load_dwordx4 s[8:11], s[0:1], 16
    s_load_dwordx4 s[68:71], s[0:1], 56
    s_load_dwordx2 s[78:79], s[0:1], 96
    s_and_b32 s16, s2, 31
    s_lshr_b32 s17, s2, 5
    v_lshrrev_b32 v2, 6, v0
    v_and_b32 v1, 63, v0
    s_nop 0
    v_readfirstlane_b32 s18, v2
    v_lshrrev_b32 v2, 4, v1
    v_and_b32 v3, 15, v1
    s_mov_b32 s19, s18
    s_and_b32 s19, s18, 3
    v_lshlrev_b32 v4, 4, v1
    v_lshrrev_b32 v28, 2, v3
    v_lshl_add_u32 v28, v2, 2, v28
    v_and_b32 v29, 7, v28
    v_and_b32 v30, 3, v3
    v_and_b32 v31, 7, v1
    v_mul_u32_u24 v31, 1040, v31
    v_lshl_add_u32 v31, v2, 3, v31
    s_lshl_b32 s64, s19, 8
    s_add_u32 s64, s64, 131072
    v_add_u32 v31, s64, v31
    s_waitcnt lgkmcnt(0)
    s_mov_b32 s20, s4
    s_and_b32 s21, s5, 0xffff
    s_mov_b32 s22, 8192
    s_mov_b32 s23, 0x00020000
    s_mov_b32 s24, s8
    s_and_b32 s25, s9, 0xffff
    s_mov_b32 s26, 4194304
    s_mov_b32 s27, 0x00020000
    s_mov_b32 s28, s10
    s_and_b32 s29, s11, 0xffff
    s_mov_b32 s30, 4194304
    s_mov_b32 s31, 0x00020000
    s_mov_b32 s32, s68
    s_and_b32 s33, s69, 0xffff
    s_mov_b32 s34, 1409024
    s_mov_b32 s35, 0x00020000
    s_mov_b32 s36, s70
    s_and_b32 s37, s71, 0xffff
    s_mov_b32 s38, 1409024
    s_mov_b32 s39, 0x00020000
    s_mov_b32 s40, s78
    s_and_b32 s41, s79, 0xffff
    s_mov_b32 s42, 23068672
    s_mov_b32 s43, 0x00020000
    s_mov_b32 s44, s6
    s_and_b32 s45, s7, 0xffff
    s_mov_b32 s46, 33554432
    s_mov_b32 s47, 0x00020000
    s_cmp_ge_u32 s18, 4
    s_cbranch_scc1 K1_B
    v_lshlrev_b32 v6, 1, v2
    v_xor_b32 v6, v6, v3
    v_lshlrev_b32 v6, 4, v6
    v_lshl_add_u32 v6, v2, 13, v6
    v_xor_b32 v7, 0x80, v6
    s_lshl_b32 s64, s19, 20
    s_lshl_b32 s65, s16, 8
    s_add_u32 s64, s64, s65
    s_lshl_b32 s66, s19, 15
    s_mov_b32 m0, s66
    s_barrier
    buffer_load_dwordx4 v6, s[24:27], s64 offen lds
    s_add_u32 m0, m0, 1024
    s_add_u32 s64, s64, 32768
    buffer_load_dwordx4 v7, s[24:27], s64 offen lds
    s_add_u32 m0, m0, 1024
    s_add_u32 s64, s64, 32768
    buffer_load_dwordx4 v6, s[24:27], s64 offen lds
    s_add_u32 m0, m0, 1024
    s_add_u32 s64, s64, 32768
    buffer_load_dwordx4 v7, s[24:27], s64 offen lds
    s_add_u32 m0, m0, 1024
    s_add_u32 s64, s64, 32768
    buffer_load_dwordx4 v6, s[24:27], s64 offen lds
    s_add_u32 m0, m0, 1024
    s_add_u32 s64, s64, 32768
    buffer_load_dwordx4 v7, s[24:27], s64 offen lds
    s_add_u32 m0, m0, 1024
    s_add_u32 s64, s64, 32768
    buffer_load_dwordx4 v6, s[24:27], s64 offen lds
    s_add_u32 m0, m0, 1024
    s_add_u32 s64, s64, 32768
    buffer_load_dwordx4 v7, s[24:27], s64 offen lds
    s_add_u32 m0, m0, 1024
    s_add_u32 s64, s64, 32768
    buffer_load_dwordx4 v6, s[24:27], s64 offen lds
    s_add_u32 m0, m0, 1024
    s_add_u32 s64, s64, 32768
    buffer_load_dwordx4 v7, s[24:27], s64 offen lds
    s_add_u32 m0, m0, 1024
    s_add_u32 s64, s64, 32768
    buffer_load_dwordx4 v6, s[24:27], s64 offen lds
    s_add_u32 m0, m0, 1024
    s_add_u32 s64, s64, 32768
    buffer_load_dwordx4 v7, s[24:27], s64 offen lds
    s_add_u32 m0, m0, 1024
    s_add_u32 s64, s64, 32768
    buffer_load_dwordx4 v6, s[24:27], s64 offen lds
    s_add_u32 m0, m0, 1024
    s_add_u32 s64, s64, 32768
    buffer_load_dwordx4 v7, s[24:27], s64 offen lds
    s_add_u32 m0, m0, 1024
    s_add_u32 s64, s64, 32768
    buffer_load_dwordx4 v6, s[24:27], s64 offen lds
    s_add_u32 m0, m0, 1024
    s_add_u32 s64, s64, 32768
    buffer_load_dwordx4 v7, s[24:27], s64 offen lds
    s_add_u32 m0, m0, 1024
    s_add_u32 s64, s64, 32768
    buffer_load_dwordx4 v6, s[24:27], s64 offen lds
    s_add_u32 m0, m0, 1024
    s_add_u32 s64, s64, 32768
    buffer_load_dwordx4 v7, s[24:27], s64 offen lds
    s_add_u32 m0, m0, 1024
    s_add_u32 s64, s64, 32768
    buffer_load_dwordx4 v6, s[24:27], s64 offen lds
    s_add_u32 m0, m0, 1024
    s_add_u32 s64, s64, 32768
    buffer_load_dwordx4 v7, s[24:27], s64 offen lds
    s_add_u32 m0, m0, 1024
    s_add_u32 s64, s64, 32768
    buffer_load_dwordx4 v6, s[24:27], s64 offen lds
    s_add_u32 m0, m0, 1024
    s_add_u32 s64, s64, 32768
    buffer_load_dwordx4 v7, s[24:27], s64 offen lds
    s_add_u32 m0, m0, 1024
    s_add_u32 s64, s64, 32768
    buffer_load_dwordx4 v6, s[24:27], s64 offen lds
    s_add_u32 m0, m0, 1024
    s_add_u32 s64, s64, 32768
    buffer_load_dwordx4 v7, s[24:27], s64 offen lds
    s_add_u32 m0, m0, 1024
    s_add_u32 s64, s64, 32768
    buffer_load_dwordx4 v6, s[24:27], s64 offen lds
    s_add_u32 m0, m0, 1024
    s_add_u32 s64, s64, 32768
    buffer_load_dwordx4 v7, s[24:27], s64 offen lds
    s_add_u32 m0, m0, 1024
    s_add_u32 s64, s64, 32768
    buffer_load_dwordx4 v6, s[24:27], s64 offen lds
    s_add_u32 m0, m0, 1024
    s_add_u32 s64, s64, 32768
    buffer_load_dwordx4 v7, s[24:27], s64 offen lds
    s_add_u32 m0, m0, 1024
    s_add_u32 s64, s64, 32768
    buffer_load_dwordx4 v6, s[24:27], s64 offen lds
    s_add_u32 m0, m0, 1024
    s_add_u32 s64, s64, 32768
    buffer_load_dwordx4 v7, s[24:27], s64 offen lds
    s_add_u32 m0, m0, 1024
    s_add_u32 s64, s64, 32768
    buffer_load_dwordx4 v6, s[24:27], s64 offen lds
    s_add_u32 m0, m0, 1024
    s_add_u32 s64, s64, 32768
    buffer_load_dwordx4 v7, s[24:27], s64 offen lds
    v_lshlrev_b32 v8, 13, v3
    v_lshl_add_u32 v8, v2, 4, v8
    s_lshl_b32 s64, s17, 6
    s_lshl_b32 s66, s19, 4
    s_add_u32 s64, s64, s66
    s_lshl_b32 s64, s64, 13
    s_add_u32 s64, s64, s65
    buffer_load_dwordx4 v[80:83], v8, s[28:31], s64 offen offset:0
    buffer_load_dwordx4 v[84:87], v8, s[28:31], s64 offen offset:64
    buffer_load_dwordx4 v[88:91], v8, s[28:31], s64 offen offset:128
    buffer_load_dwordx4 v[92:95], v8, s[28:31], s64 offen offset:192
    v_and_b32 v70, 7, v1
    v_mul_u32_u24 v70, 1040, v70
    v_lshl_add_u32 v70, v2, 3, v70
    v_add_u32 v70, 131072, v70
    s_lshl_b32 s64, s19, 1
    v_xor_b32 v73, s64, v29
    v_lshlrev_b32 v74, 8, v28
    v_lshl_add_u32 v74, v73, 5, v74
    v_lshl_add_u32 v74, v30, 3, v74
    v_xor_b32 v75, 32, v74
    v_add_u32 v76, 0x10000, v74
    v_add_u32 v77, 0x10000, v75
    v_mul_u32_u24 v24, 1088, v2
    v_lshl_add_u32 v24, v3, 1, v24
    s_lshl_b32 s64, s19, 6
    s_add_u32 s64, s64, 139392
    v_add_u32 v24, s64, v24
    v_mul_u32_u24 v25, 272, v3
    v_lshl_add_u32 v25, v2, 4, v25
    v_add_u32 v25, 139392, v25
    v_lshlrev_b32 v26, 15, v3
    v_lshl_add_u32 v26, v2, 3, v26
    v_cmp_lt_u32 vcc, 7, v3
    v_mov_b32 v27, 0x7f000000
    s_lshl_b32 s70, s16, 10
    s_lshl_b32 s65, s17, 7
    v_cndmask_b32 v26, v26, v27, vcc
    s_add_u32 s70, s70, s65
    s_lshl_b32 s65, s19, 5
    s_add_u32 s70, s70, s65
    v_mov_b32 v8, 0
    v_mov_b32 v9, 0
    v_mov_b32 v10, 0
    v_mov_b32 v11, 0
    v_mov_b32 v12, 0
    v_mov_b32 v13, 0
    v_mov_b32 v14, 0
    v_mov_b32 v15, 0
    v_mov_b32 v16, 0
    v_mov_b32 v17, 0
    v_mov_b32 v18, 0
    v_mov_b32 v19, 0
    s_waitcnt vmcnt(4)
    s_barrier
    ds_read2_b64 v[128:131], v70 offset0:0 offset1:4
    ds_read_b64_tr_b16 v[144:145], v74 offset:0
    ds_read_b64_tr_b16 v[146:147], v74 offset:4096
    ds_read_b64_tr_b16 v[148:149], v75 offset:0
    ds_read_b64_tr_b16 v[150:151], v75 offset:4096
    ds_read2_b64 v[132:135], v70 offset0:8 offset1:12
    ds_read_b64_tr_b16 v[152:153], v74 offset:8192
    ds_read_b64_tr_b16 v[154:155], v74 offset:12288
    ds_read_b64_tr_b16 v[156:157], v75 offset:8192
    ds_read_b64_tr_b16 v[158:159], v75 offset:12288
    ds_read2_b64 v[136:139], v70 offset0:16 offset1:20
    ds_read_b64_tr_b16 v[160:161], v74 offset:16384
    ds_read_b64_tr_b16 v[162:163], v74 offset:20480
    ds_read_b64_tr_b16 v[164:165], v75 offset:16384
    ds_read_b64_tr_b16 v[166:167], v75 offset:20480
    s_waitcnt lgkmcnt(10)
    ds_read2_b64 v[140:143], v70 offset0:24 offset1:28
    ds_read_b64_tr_b16 v[168:169], v74 offset:24576
    ds_read_b64_tr_b16 v[170:171], v74 offset:28672
    ds_read_b64_tr_b16 v[172:173], v75 offset:24576
    ds_read_b64_tr_b16 v[174:175], v75 offset:28672
    s_waitcnt lgkmcnt(15)
    v_mfma_f32_16x16x32_bf16 v[8:11], v[128:131], v[144:147], v[8:11]
    v_mfma_f32_16x16x32_bf16 v[12:15], v[128:131], v[148:151], v[12:15]
    s_waitcnt lgkmcnt(10)
    v_mfma_f32_16x16x32_bf16 v[8:11], v[132:135], v[152:155], v[8:11]
    v_mfma_f32_16x16x32_bf16 v[12:15], v[132:135], v[156:159], v[12:15]
    s_waitcnt lgkmcnt(5)
    v_mfma_f32_16x16x32_bf16 v[8:11], v[136:139], v[160:163], v[8:11]
    v_mfma_f32_16x16x32_bf16 v[12:15], v[136:139], v[164:167], v[12:15]
    s_waitcnt lgkmcnt(0)
    v_mfma_f32_16x16x32_bf16 v[8:11], v[140:143], v[168:171], v[8:11]
    v_mfma_f32_16x16x32_bf16 v[12:15], v[140:143], v[172:175], v[12:15]
    ds_read2_b64 v[192:195], v70 offset0:32 offset1:36
    ds_read_b64_tr_b16 v[208:209], v74 offset:32768
    ds_read_b64_tr_b16 v[210:211], v74 offset:36864
    ds_read_b64_tr_b16 v[212:213], v75 offset:32768
    ds_read_b64_tr_b16 v[214:215], v75 offset:36864
    ds_read2_b64 v[196:199], v70 offset0:40 offset1:44
    ds_read_b64_tr_b16 v[216:217], v74 offset:40960
    ds_read_b64_tr_b16 v[218:219], v74 offset:45056
    ds_read_b64_tr_b16 v[220:221], v75 offset:40960
    ds_read_b64_tr_b16 v[222:223], v75 offset:45056
    ds_read2_b64 v[200:203], v70 offset0:48 offset1:52
    ds_read_b64_tr_b16 v[224:225], v74 offset:49152
    ds_read_b64_tr_b16 v[226:227], v74 offset:53248
    ds_read_b64_tr_b16 v[228:229], v75 offset:49152
    ds_read_b64_tr_b16 v[230:231], v75 offset:53248
    s_waitcnt lgkmcnt(10)
    ds_read2_b64 v[204:207], v70 offset0:56 offset1:60
    ds_read_b64_tr_b16 v[232:233], v74 offset:57344
    ds_read_b64_tr_b16 v[234:235], v74 offset:61440
    ds_read_b64_tr_b16 v[236:237], v75 offset:57344
    ds_read_b64_tr_b16 v[238:239], v75 offset:61440
    s_waitcnt lgkmcnt(15)
    v_mfma_f32_16x16x32_bf16 v[8:11], v[192:195], v[208:211], v[8:11]
    v_mfma_f32_16x16x32_bf16 v[12:15], v[192:195], v[212:215], v[12:15]
    s_waitcnt lgkmcnt(10)
    v_mfma_f32_16x16x32_bf16 v[8:11], v[196:199], v[216:219], v[8:11]
    v_mfma_f32_16x16x32_bf16 v[12:15], v[196:199], v[220:223], v[12:15]
    s_waitcnt lgkmcnt(5)
    v_mfma_f32_16x16x32_bf16 v[8:11], v[200:203], v[224:227], v[8:11]
    v_mfma_f32_16x16x32_bf16 v[12:15], v[200:203], v[228:231], v[12:15]
    s_waitcnt lgkmcnt(0)
    v_mfma_f32_16x16x32_bf16 v[8:11], v[204:207], v[232:235], v[8:11]
    v_mfma_f32_16x16x32_bf16 v[12:15], v[204:207], v[236:239], v[12:15]
    ds_read2_b64 v[128:131], v70 offset0:64 offset1:68
    ds_read_b64_tr_b16 v[144:145], v76 offset:0
    ds_read_b64_tr_b16 v[146:147], v76 offset:4096
    ds_read_b64_tr_b16 v[148:149], v77 offset:0
    ds_read_b64_tr_b16 v[150:151], v77 offset:4096
    ds_read2_b64 v[132:135], v70 offset0:72 offset1:76
    ds_read_b64_tr_b16 v[152:153], v76 offset:8192
    ds_read_b64_tr_b16 v[154:155], v76 offset:12288
    ds_read_b64_tr_b16 v[156:157], v77 offset:8192
    ds_read_b64_tr_b16 v[158:159], v77 offset:12288
    ds_read2_b64 v[136:139], v70 offset0:80 offset1:84
    ds_read_b64_tr_b16 v[160:161], v76 offset:16384
    ds_read_b64_tr_b16 v[162:163], v76 offset:20480
    ds_read_b64_tr_b16 v[164:165], v77 offset:16384
    ds_read_b64_tr_b16 v[166:167], v77 offset:20480
    s_waitcnt lgkmcnt(10)
    ds_read2_b64 v[140:143], v70 offset0:88 offset1:92
    ds_read_b64_tr_b16 v[168:169], v76 offset:24576
    ds_read_b64_tr_b16 v[170:171], v76 offset:28672
    ds_read_b64_tr_b16 v[172:173], v77 offset:24576
    ds_read_b64_tr_b16 v[174:175], v77 offset:28672
    s_waitcnt lgkmcnt(15)
    v_mfma_f32_16x16x32_bf16 v[8:11], v[128:131], v[144:147], v[8:11]
    v_mfma_f32_16x16x32_bf16 v[12:15], v[128:131], v[148:151], v[12:15]
    s_waitcnt lgkmcnt(10)
    v_mfma_f32_16x16x32_bf16 v[8:11], v[132:135], v[152:155], v[8:11]
    v_mfma_f32_16x16x32_bf16 v[12:15], v[132:135], v[156:159], v[12:15]
    s_waitcnt lgkmcnt(5)
    v_mfma_f32_16x16x32_bf16 v[8:11], v[136:139], v[160:163], v[8:11]
    v_mfma_f32_16x16x32_bf16 v[12:15], v[136:139], v[164:167], v[12:15]
    s_waitcnt lgkmcnt(0)
    v_mfma_f32_16x16x32_bf16 v[8:11], v[140:143], v[168:171], v[8:11]
    v_mfma_f32_16x16x32_bf16 v[12:15], v[140:143], v[172:175], v[12:15]
    ds_read2_b64 v[192:195], v70 offset0:96 offset1:100
    ds_read_b64_tr_b16 v[208:209], v76 offset:32768
    ds_read_b64_tr_b16 v[210:211], v76 offset:36864
    ds_read_b64_tr_b16 v[212:213], v77 offset:32768
    ds_read_b64_tr_b16 v[214:215], v77 offset:36864
    ds_read2_b64 v[196:199], v70 offset0:104 offset1:108
    ds_read_b64_tr_b16 v[216:217], v76 offset:40960
    ds_read_b64_tr_b16 v[218:219], v76 offset:45056
    ds_read_b64_tr_b16 v[220:221], v77 offset:40960
    ds_read_b64_tr_b16 v[222:223], v77 offset:45056
    ds_read2_b64 v[200:203], v70 offset0:112 offset1:116
    ds_read_b64_tr_b16 v[224:225], v76 offset:49152
    ds_read_b64_tr_b16 v[226:227], v76 offset:53248
    ds_read_b64_tr_b16 v[228:229], v77 offset:49152
    ds_read_b64_tr_b16 v[230:231], v77 offset:53248
    s_waitcnt lgkmcnt(10)
    ds_read2_b64 v[204:207], v70 offset0:120 offset1:124
    ds_read_b64_tr_b16 v[232:233], v76 offset:57344
    ds_read_b64_tr_b16 v[234:235], v76 offset:61440
    ds_read_b64_tr_b16 v[236:237], v77 offset:57344
    ds_read_b64_tr_b16 v[238:239], v77 offset:61440
    s_waitcnt lgkmcnt(15)
    v_mfma_f32_16x16x32_bf16 v[8:11], v[192:195], v[208:211], v[8:11]
    v_mfma_f32_16x16x32_bf16 v[12:15], v[192:195], v[212:215], v[12:15]
    s_waitcnt lgkmcnt(10)
    v_mfma_f32_16x16x32_bf16 v[8:11], v[196:199], v[216:219], v[8:11]
    v_mfma_f32_16x16x32_bf16 v[12:15], v[196:199], v[220:223], v[12:15]
    s_waitcnt lgkmcnt(5)
    v_mfma_f32_16x16x32_bf16 v[8:11], v[200:203], v[224:227], v[8:11]
    v_mfma_f32_16x16x32_bf16 v[12:15], v[200:203], v[228:231], v[12:15]
    s_waitcnt lgkmcnt(0)
    v_mfma_f32_16x16x32_bf16 v[8:11], v[204:207], v[232:235], v[8:11]
    v_mfma_f32_16x16x32_bf16 v[12:15], v[204:207], v[236:239], v[12:15]
    s_nop 7
    v_cvt_pk_bf16_f32 v20, v8, v9
    v_cvt_pk_bf16_f32 v21, v10, v11
    v_cvt_pk_bf16_f32 v22, v12, v13
    v_cvt_pk_bf16_f32 v23, v14, v15
    ds_write_b16 v24, v20 offset:0
    ds_write_b16_d16_hi v24, v20 offset:272
    ds_write_b16 v24, v21 offset:544
    ds_write_b16_d16_hi v24, v21 offset:816
    ds_write_b16 v24, v22 offset:32
    ds_write_b16_d16_hi v24, v22 offset:304
    ds_write_b16 v24, v23 offset:576
    ds_write_b16_d16_hi v24, v23 offset:848
    s_waitcnt lgkmcnt(0)
    s_barrier
    ds_read_b128 v[128:131], v25 offset:0
    ds_read_b128 v[132:135], v25 offset:64
    ds_read_b128 v[136:139], v25 offset:128
    ds_read_b128 v[140:143], v25 offset:192
    s_waitcnt vmcnt(0) lgkmcnt(0)
    v_mfma_f32_16x16x32_bf16 v[16:19], v[80:83], v[128:131], v[16:19]
    v_mfma_f32_16x16x32_bf16 v[16:19], v[84:87], v[132:135], v[16:19]
    v_mfma_f32_16x16x32_bf16 v[16:19], v[88:91], v[136:139], v[16:19]
    v_mfma_f32_16x16x32_bf16 v[16:19], v[92:95], v[140:143], v[16:19]
    s_nop 7
    v_cvt_pk_bf16_f32 v12, v16, v17
    v_cvt_pk_bf16_f32 v13, v18, v19
    buffer_store_dwordx2 v[12:13], v26, s[40:43], s70 offen
    s_branch K1_END
K1_B:
    s_lshl_b32 s64, s19, 11
    v_lshlrev_b32 v5, 5, v1
    buffer_load_dwordx4 v[48:51], v5, s[20:23], s64 offen
    buffer_load_dwordx4 v[52:55], v5, s[20:23], s64 offen offset:16
    s_and_b32 s74, s2, 7
    s_mul_i32 s74, s74, 11
    s_lshr_b32 s75, s2, 3
    s_add_u32 s74, s74, s75
    s_cmp_ge_u32 s2, 88
    s_cselect_b32 s74, 0x1000, s74
    v_lshrrev_b32 v24, 1, v1
    v_mul_u32_u24 v24, 2752, v24
    v_and_b32 v25, 1, v1
    v_lshl_add_u32 v24, v25, 4, v24
    s_mul_i32 s64, s19, 352256
    s_lshl_b32 s65, s74, 5
    s_add_u32 s64, s64, s65
    s_cmp_ge_u32 s74, 86
    s_cselect_b32 s64, 0x40000000, s64
    buffer_load_dwordx4 v[96:99], v24, s[32:35], s64 offen
    buffer_load_dwordx4 v[112:115], v24, s[36:39], s64 offen
    s_add_u32 s64, s64, 88064
    buffer_load_dwordx4 v[100:103], v24, s[32:35], s64 offen
    buffer_load_dwordx4 v[116:119], v24, s[36:39], s64 offen
    s_add_u32 s64, s64, 88064
    buffer_load_dwordx4 v[104:107], v24, s[32:35], s64 offen
    buffer_load_dwordx4 v[120:123], v24, s[36:39], s64 offen
    s_add_u32 s64, s64, 88064
    buffer_load_dwordx4 v[108:111], v24, s[32:35], s64 offen
    buffer_load_dwordx4 v[124:127], v24, s[36:39], s64 offen
    s_barrier
    s_lshl_b32 s76, s2, 17
    s_lshl_b32 s64, s19, 15
    s_add_u32 s76, s76, s64
    s_waitcnt vmcnt(8)
    v_lshlrev_b32 v56, 16, v48
    v_and_b32 v57, 0xffff0000, v48
    v_lshlrev_b32 v58, 16, v49
    v_and_b32 v59, 0xffff0000, v49
    v_lshlrev_b32 v60, 16, v50
    v_and_b32 v61, 0xffff0000, v50
    v_lshlrev_b32 v62, 16, v51
    v_and_b32 v63, 0xffff0000, v51
    v_lshlrev_b32 v64, 16, v52
    v_and_b32 v65, 0xffff0000, v52
    v_lshlrev_b32 v66, 16, v53
    v_and_b32 v67, 0xffff0000, v53
    v_lshlrev_b32 v68, 16, v54
    v_and_b32 v69, 0xffff0000, v54
    v_lshlrev_b32 v70, 16, v55
    v_and_b32 v71, 0xffff0000, v55
    v_add_f32 v8, v56, v57
    v_add_f32 v9, v58, v59
    v_add_f32 v10, v60, v61
    v_add_f32 v11, v62, v63
    v_add_f32 v8, v8, v64
    v_add_f32 v9, v9, v65
    v_add_f32 v10, v10, v66
    v_add_f32 v11, v11, v67
    v_add_f32 v8, v8, v68
    v_add_f32 v9, v9, v69
    v_add_f32 v10, v10, v70
    v_add_f32 v11, v11, v71
    v_add_f32 v8, v8, v9
    v_add_f32 v10, v10, v11
    v_add_f32 v8, v8, v10
    s_nop 1
    v_add_f32_dpp v8, v8, v8 quad_perm:[1,0,3,2] row_mask:0xf bank_mask:0xf
    s_nop 1
    v_add_f32_dpp v8, v8, v8 quad_perm:[2,3,0,1] row_mask:0xf bank_mask:0xf
    s_nop 1
    v_add_f32_dpp v8, v8, v8 row_half_mirror row_mask:0xf bank_mask:0xf
    s_nop 1
    v_add_f32_dpp v8, v8, v8 row_mirror row_mask:0xf bank_mask:0xf
    v_mov_b32 v9, v8
    s_nop 1
    v_permlane16_swap_b32 v8, v9
    s_nop 1
    v_add_f32 v8, v8, v9
    v_mul_f32 v8, 0x3b000000, v8
    v_sub_f32 v72, v56, v8
    v_sub_f32 v73, v57, v8
    v_sub_f32 v74, v58, v8
    v_sub_f32 v75, v59, v8
    v_sub_f32 v76, v60, v8
    v_sub_f32 v77, v61, v8
    v_sub_f32 v78, v62, v8
    v_sub_f32 v79, v63, v8
    v_sub_f32 v80, v64, v8
    v_sub_f32 v81, v65, v8
    v_sub_f32 v82, v66, v8
    v_sub_f32 v83, v67, v8
    v_sub_f32 v84, v68, v8
    v_sub_f32 v85, v69, v8
    v_sub_f32 v86, v70, v8
    v_sub_f32 v87, v71, v8
    v_mul_f32 v9, v72, v72
    v_mul_f32 v10, v73, v73
    v_mul_f32 v11, v74, v74
    v_mul_f32 v12, v75, v75
    v_fmac_f32 v9, v76, v76
    v_fmac_f32 v10, v77, v77
    v_fmac_f32 v11, v78, v78
    v_fmac_f32 v12, v79, v79
    v_fmac_f32 v9, v80, v80
    v_fmac_f32 v10, v81, v81
    v_fmac_f32 v11, v82, v82
    v_fmac_f32 v12, v83, v83
    v_fmac_f32 v9, v84, v84
    v_fmac_f32 v10, v85, v85
    v_fmac_f32 v11, v86, v86
    v_fmac_f32 v12, v87, v87
    v_add_f32 v9, v9, v10
    v_add_f32 v11, v11, v12
    v_add_f32 v12, v9, v11
    s_nop 1
    v_add_f32_dpp v12, v12, v12 quad_perm:[1,0,3,2] row_mask:0xf bank_mask:0xf
    s_nop 1
    v_add_f32_dpp v12, v12, v12 quad_perm:[2,3,0,1] row_mask:0xf bank_mask:0xf
    s_nop 1
    v_add_f32_dpp v12, v12, v12 row_half_mirror row_mask:0xf bank_mask:0xf
    s_nop 1
    v_add_f32_dpp v12, v12, v12 row_mirror row_mask:0xf bank_mask:0xf
    v_mov_b32 v9, v12
    s_nop 1
    v_permlane16_swap_b32 v12, v9
    s_nop 1
    v_add_f32 v12, v12, v9
    v_mul_f32 v12, 0x3b000000, v12
    v_cvt_pk_bf16_f32 v9, v8, v12
    v_lshlrev_b32 v8, 16, v9
    v_and_b32 v12, 0xffff0000, v9
    v_add_f32 v12, 0x3727c5ac, v12
    v_cvt_pk_bf16_f32 v12, v12, v12
    v_lshlrev_b32 v12, 16, v12
    v_sqrt_f32 v12, v12
    s_nop 0
    v_cvt_pk_bf16_f32 v12, v12, v12
    v_lshlrev_b32 v12, 16, v12
    v_rcp_f32 v9, v12
    v_sub_f32 v56, v56, v8
    v_sub_f32 v57, v57, v8
    v_sub_f32 v58, v58, v8
    v_sub_f32 v59, v59, v8
    v_sub_f32 v60, v60, v8
    v_sub_f32 v61, v61, v8
    v_sub_f32 v62, v62, v8
    v_sub_f32 v63, v63, v8
    v_sub_f32 v64, v64, v8
    v_sub_f32 v65, v65, v8
    v_sub_f32 v66, v66, v8
    v_sub_f32 v67, v67, v8
    v_sub_f32 v68, v68, v8
    v_sub_f32 v69, v69, v8
    v_sub_f32 v70, v70, v8
    v_sub_f32 v71, v71, v8
    v_cvt_pk_bf16_f32 v72, v56, v57
    v_cvt_pk_bf16_f32 v73, v58, v59
    v_cvt_pk_bf16_f32 v74, v60, v61
    v_cvt_pk_bf16_f32 v75, v62, v63
    v_cvt_pk_bf16_f32 v76, v64, v65
    v_cvt_pk_bf16_f32 v77, v66, v67
    v_cvt_pk_bf16_f32 v78, v68, v69
    v_cvt_pk_bf16_f32 v79, v70, v71
    v_lshlrev_b32 v56, 16, v72
    v_and_b32 v57, 0xffff0000, v72
    v_lshlrev_b32 v58, 16, v73
    v_and_b32 v59, 0xffff0000, v73
    v_lshlrev_b32 v60, 16, v74
    v_and_b32 v61, 0xffff0000, v74
    v_lshlrev_b32 v62, 16, v75
    v_and_b32 v63, 0xffff0000, v75
    v_lshlrev_b32 v64, 16, v76
    v_and_b32 v65, 0xffff0000, v76
    v_lshlrev_b32 v66, 16, v77
    v_and_b32 v67, 0xffff0000, v77
    v_lshlrev_b32 v68, 16, v78
    v_and_b32 v69, 0xffff0000, v78
    v_lshlrev_b32 v70, 16, v79
    v_and_b32 v71, 0xffff0000, v79
    v_mul_f32 v56, v56, v9
    v_mul_f32 v57, v57, v9
    v_mul_f32 v58, v58, v9
    v_mul_f32 v59, v59, v9
    v_mul_f32 v60, v60, v9
    v_mul_f32 v61, v61, v9
    v_mul_f32 v62, v62, v9
    v_mul_f32 v63, v63, v9
    v_mul_f32 v64, v64, v9
    v_mul_f32 v65, v65, v9
    v_mul_f32 v66, v66, v9
    v_mul_f32 v67, v67, v9
    v_mul_f32 v68, v68, v9
    v_mul_f32 v69, v69, v9
    v_mul_f32 v70, v70, v9
    v_mul_f32 v71, v71, v9
    v_cvt_pk_bf16_f32 v72, v56, v57
    v_cvt_pk_bf16_f32 v73, v58, v59
    v_cvt_pk_bf16_f32 v74, v60, v61
    v_cvt_pk_bf16_f32 v75, v62, v63
    v_cvt_pk_bf16_f32 v76, v64, v65
    v_cvt_pk_bf16_f32 v77, v66, v67
    v_cvt_pk_bf16_f32 v78, v68, v69
    v_cvt_pk_bf16_f32 v79, v70, v71
    v_lshrrev_b32 v10, 5, v1
    s_lshl_b32 s64, s19, 1
    v_add_u32 v10, s64, v10
    v_mul_u32_u24 v10, 1040, v10
    v_and_b32 v11, 31, v1
    v_lshl_add_u32 v10, v11, 5, v10
    v_add_u32 v10, 131072, v10
    ds_write_b128 v10, v[72:75]
    ds_write_b128 v10, v[76:79] offset:16
    s_waitcnt lgkmcnt(0)
    s_barrier
    s_cmp_ge_u32 s74, 86
    s_cbranch_scc1 K1_BNOF
    ds_read2_b64 v[32:35], v31 offset0:0 offset1:4
    ds_read2_b64 v[36:39], v31 offset0:8 offset1:12
    ds_read2_b64 v[40:43], v31 offset0:16 offset1:20
    ds_read2_b64 v[44:47], v31 offset0:24 offset1:28
    s_lshl_b32 s66, s19, 12
    s_add_u32 s66, s66, 143872
    v_add_u32 v25, s66, v4
    v_lshlrev_b32 v26, 5, v28
    v_lshl_add_u32 v26, v30, 3, v26
    v_add_u32 v26, s66, v26
    v_mov_b32 v8, 0
    v_mov_b32 v9, 0
    v_mov_b32 v10, 0
    v_mov_b32 v11, 0
    v_mov_b32 v12, 0
    v_mov_b32 v13, 0
    v_mov_b32 v14, 0
    v_mov_b32 v15, 0
    s_waitcnt vmcnt(0)
    ds_write_b128 v25, v[96:99] offset:0
    ds_write_b128 v25, v[100:103] offset:1024
    ds_write_b128 v25, v[104:107] offset:2048
    ds_write_b128 v25, v[108:111] offset:3072
    ds_read_b64_tr_b16 v[128:129], v26 offset:0
    ds_read_b64_tr_b16 v[130:131], v26 offset:512
    ds_read_b64_tr_b16 v[132:133], v26 offset:1024
    ds_read_b64_tr_b16 v[134:135], v26 offset:1536
    ds_read_b64_tr_b16 v[136:137], v26 offset:2048
    ds_read_b64_tr_b16 v[138:139], v26 offset:2560
    ds_read_b64_tr_b16 v[140:141], v26 offset:3072
    ds_read_b64_tr_b16 v[142:143], v26 offset:3584
    ds_write_b128 v25, v[112:115] offset:0
    ds_write_b128 v25, v[116:119] offset:1024
    ds_write_b128 v25, v[120:123] offset:2048
    ds_write_b128 v25, v[124:127] offset:3072
    ds_read_b64_tr_b16 v[144:145], v26 offset:0
    ds_read_b64_tr_b16 v[146:147], v26 offset:512
    ds_read_b64_tr_b16 v[148:149], v26 offset:1024
    ds_read_b64_tr_b16 v[150:151], v26 offset:1536
    ds_read_b64_tr_b16 v[152:153], v26 offset:2048
    ds_read_b64_tr_b16 v[154:155], v26 offset:2560
    ds_read_b64_tr_b16 v[156:157], v26 offset:3072
    ds_read_b64_tr_b16 v[158:159], v26 offset:3584
    s_waitcnt lgkmcnt(0)
    v_mfma_f32_16x16x32_bf16 v[8:11], v[32:35], v[128:131], v[8:11]
    v_mfma_f32_16x16x32_bf16 v[8:11], v[36:39], v[132:135], v[8:11]
    v_mfma_f32_16x16x32_bf16 v[8:11], v[40:43], v[136:139], v[8:11]
    v_mfma_f32_16x16x32_bf16 v[8:11], v[44:47], v[140:143], v[8:11]
    v_mfma_f32_16x16x32_bf16 v[12:15], v[32:35], v[144:147], v[12:15]
    v_mfma_f32_16x16x32_bf16 v[12:15], v[36:39], v[148:151], v[12:15]
    v_mfma_f32_16x16x32_bf16 v[12:15], v[40:43], v[152:155], v[12:15]
    v_mfma_f32_16x16x32_bf16 v[12:15], v[44:47], v[156:159], v[12:15]
    v_lshlrev_b32 v17, 5, v1
    v_add_u32 v18, s66, v17
    v_add_u32 v17, 143872, v17
    s_nop 7
    ds_write_b128 v18, v[8:11]
    ds_write_b128 v18, v[12:15] offset:16
K1_BNOF:
    buffer_load_dwordx4 v[160:163], v4, s[44:47], s76 offen
    s_add_u32 s76, s76, 1024
    buffer_load_dwordx4 v[164:167], v4, s[44:47], s76 offen
    s_add_u32 s76, s76, 1024
    buffer_load_dwordx4 v[168:171], v4, s[44:47], s76 offen
    s_add_u32 s76, s76, 1024
    buffer_load_dwordx4 v[172:175], v4, s[44:47], s76 offen
    s_add_u32 s76, s76, 1024
    buffer_load_dwordx4 v[176:179], v4, s[44:47], s76 offen
    s_add_u32 s76, s76, 1024
    buffer_load_dwordx4 v[180:183], v4, s[44:47], s76 offen
    s_add_u32 s76, s76, 1024
    buffer_load_dwordx4 v[184:187], v4, s[44:47], s76 offen
    s_add_u32 s76, s76, 1024
    buffer_load_dwordx4 v[188:191], v4, s[44:47], s76 offen
    s_add_u32 s76, s76, 1024
    buffer_load_dwordx4 v[192:195], v4, s[44:47], s76 offen
    s_add_u32 s76, s76, 1024
    buffer_load_dwordx4 v[196:199], v4, s[44:47], s76 offen
    s_add_u32 s76, s76, 1024
    buffer_load_dwordx4 v[200:203], v4, s[44:47], s76 offen
    s_add_u32 s76, s76, 1024
    buffer_load_dwordx4 v[204:207], v4, s[44:47], s76 offen
    s_add_u32 s76, s76, 1024
    s_waitcnt lgkmcnt(0)
    s_barrier
    s_cmp_ge_u32 s74, 86
    s_cbranch_scc1 K1_BEND
    s_cmp_lg_u32 s18, 4
    s_cbranch_scc1 K1_BEND
    ds_read_b128 v[104:107], v17 offset:4096
    ds_read_b128 v[108:111], v17 offset:4112
    ds_read_b128 v[112:115], v17 offset:8192
    ds_read_b128 v[116:119], v17 offset:8208
    ds_read_b128 v[120:123], v17 offset:12288
    ds_read_b128 v[124:127], v17 offset:12304
    s_waitcnt lgkmcnt(0)
    v_add_f32 v8, v8, v104
    v_add_f32 v9, v9, v105
    v_add_f32 v10, v10, v106
    v_add_f32 v11, v11, v107
    v_add_f32 v12, v12, v108
    v_add_f32 v13, v13, v109
    v_add_f32 v14, v14, v110
    v_add_f32 v15, v15, v111
    v_add_f32 v8, v8, v112
    v_add_f32 v9, v9, v113
    v_add_f32 v10, v10, v114
    v_add_f32 v11, v11, v115
    v_add_f32 v12, v12, v116
    v_add_f32 v13, v13, v117
    v_add_f32 v14, v14, v118
    v_add_f32 v15, v15, v119
    v_add_f32 v8, v8, v120
    v_add_f32 v9, v9, v121
    v_add_f32 v10, v10, v122
    v_add_f32 v11, v11, v123
    v_add_f32 v12, v12, v124
    v_add_f32 v13, v13, v125
    v_add_f32 v14, v14, v126
    v_add_f32 v15, v15, v127
    v_cvt_pk_bf16_f32 v96, v8, v12
    v_cvt_pk_bf16_f32 v97, v9, v13
    v_cvt_pk_bf16_f32 v98, v10, v14
    v_cvt_pk_bf16_f32 v99, v11, v15
    v_lshlrev_b32 v8, 16, v96
    v_and_b32 v12, 0xffff0000, v96
    v_lshlrev_b32 v9, 16, v97
    v_and_b32 v13, 0xffff0000, v97
    v_lshlrev_b32 v10, 16, v98
    v_and_b32 v14, 0xffff0000, v98
    v_lshlrev_b32 v11, 16, v99
    v_and_b32 v15, 0xffff0000, v99
    s_mov_b32 s64, 0x3d372713
    s_mov_b32 s65, 0xc0135761
    v_mul_f32 v96, v8, v8
    v_mul_f32 v96, s64, v96
    v_fma_f32 v96, v96, v8, v8
    v_mul_f32 v96, s65, v96
    v_exp_f32 v96, v96
    s_nop 0
    v_add_f32 v96, 1.0, v96
    v_rcp_f32 v96, v96
    s_nop 0
    v_mul_f32 v96, v96, v8
    v_mul_f32 v97, v9, v9
    v_mul_f32 v97, s64, v97
    v_fma_f32 v97, v97, v9, v9
    v_mul_f32 v97, s65, v97
    v_exp_f32 v97, v97
    s_nop 0
    v_add_f32 v97, 1.0, v97
    v_rcp_f32 v97, v97
    s_nop 0
    v_mul_f32 v97, v97, v9
    v_mul_f32 v98, v10, v10
    v_mul_f32 v98, s64, v98
    v_fma_f32 v98, v98, v10, v10
    v_mul_f32 v98, s65, v98
    v_exp_f32 v98, v98
    s_nop 0
    v_add_f32 v98, 1.0, v98
    v_rcp_f32 v98, v98
    s_nop 0
    v_mul_f32 v98, v98, v10
    v_mul_f32 v99, v11, v11
    v_mul_f32 v99, s64, v99
    v_fma_f32 v99, v99, v11, v11
    v_mul_f32 v99, s65, v99
    v_exp_f32 v99, v99
    s_nop 0
    v_add_f32 v99, 1.0, v99
    v_rcp_f32 v99, v99
    s_nop 0
    v_mul_f32 v99, v99, v11
    v_cvt_pk_bf16_f32 v96, v96, v96
    v_lshlrev_b32 v96, 16, v96
    v_mul_f32 v96, v96, v12
    v_cvt_pk_bf16_f32 v96, v96, v96
    v_cvt_pk_bf16_f32 v97, v97, v97
    v_lshlrev_b32 v97, 16, v97
    v_mul_f32 v97, v97, v13
    v_cvt_pk_bf16_f32 v97, v97, v97
    v_cvt_pk_bf16_f32 v98, v98, v98
    v_lshlrev_b32 v98, 16, v98
    v_mul_f32 v98, v98, v14
    v_cvt_pk_bf16_f32 v98, v98, v98
    v_cvt_pk_bf16_f32 v99, v99, v99
    v_lshlrev_b32 v99, 16, v99
    v_mul_f32 v99, v99, v15
    v_cvt_pk_bf16_f32 v99, v99, v99
    v_mul_u32_u24 v100, 11008, v2
    v_lshl_add_u32 v100, v3, 1, v100
    v_cmp_lt_u32 vcc, 1, v2
    v_mov_b32 v101, 0x7f000000
    s_lshl_b32 s64, s74, 5
    s_add_u32 s64, s64, 262144
    v_cndmask_b32 v100, v100, v101, vcc
    v_add_u32 v101, 5504, v100
    buffer_store_short v96, v100, s[40:43], s64 offen offset:0
    buffer_store_short v97, v100, s[40:43], s64 offen offset:2752
    buffer_store_short v98, v101, s[40:43], s64 offen offset:0
    buffer_store_short v99, v101, s[40:43], s64 offen offset:2752
K1_BEND:
    s_waitcnt vmcnt(0)
K1_END:
    s_endpgm
.globl k2_kernel
.p2align 8
.type k2_kernel,@function
k2_kernel:
    s_cmp_ge_u32 s2, 256
    s_cbranch_scc1 K2_END
    s_load_dwordx2 s[4:5], s[0:1], 8
    s_load_dwordx4 s[12:15], s[0:1], 32
    s_load_dwordx2 s[72:73], s[0:1], 72
    s_load_dwordx2 s[78:79], s[0:1], 96
    s_and_b32 s16, s2, 31
    s_lshr_b32 s17, s2, 5
    v_lshrrev_b32 v2, 6, v0
    v_and_b32 v1, 63, v0
    s_nop 0
    v_readfirstlane_b32 s18, v2
    v_lshrrev_b32 v2, 4, v1
    v_and_b32 v3, 15, v1
    s_mov_b32 s19, s18
    s_and_b32 s19, s18, 3
    v_lshlrev_b32 v4, 4, v1
    v_and_b32 v8, 31, v1
    v_lshrrev_b32 v9, 5, v1
    s_waitcnt lgkmcnt(0)
    s_mov_b32 s40, s78
    s_and_b32 s41, s79, 0xffff
    s_mov_b32 s42, 23068672
    s_mov_b32 s43, 0x00020000
    s_mov_b32 s44, s4
    s_and_b32 s45, s5, 0xffff
    s_mov_b32 s46, 33554432
    s_mov_b32 s47, 0x00020000
    s_mov_b32 s48, s12
    s_and_b32 s49, s13, 0xffff
    s_mov_b32 s50, 4194304
    s_mov_b32 s51, 0x00020000
    s_mov_b32 s52, s14
    s_and_b32 s53, s15, 0xffff
    s_mov_b32 s54, 4194304
    s_mov_b32 s55, 0x00020000
    s_mov_b32 s56, s72
    s_and_b32 s57, s73, 0xffff
    s_mov_b32 s58, 1409024
    s_mov_b32 s59, 0x00020000
    s_cmp_ge_u32 s18, 4
    s_cbranch_scc1 K2_B
    s_lshl_b32 s64, s2, 17
    s_lshl_b32 s65, s19, 15
    s_add_u32 s64, s64, s65
    s_mov_b32 m0, s65
    v_xor_b32 v10, 0, v4
    buffer_load_dwordx4 v10, s[44:47], s64 offen lds
    s_add_u32 m0, m0, 1024
    s_add_u32 s64, s64, 1024
    v_xor_b32 v11, 64, v4
    buffer_load_dwordx4 v11, s[44:47], s64 offen lds
    s_add_u32 m0, m0, 1024
    s_add_u32 s64, s64, 1024
    v_xor_b32 v12, 128, v4
    buffer_load_dwordx4 v12, s[44:47], s64 offen lds
    s_add_u32 m0, m0, 1024
    s_add_u32 s64, s64, 1024
    v_xor_b32 v13, 192, v4
    buffer_load_dwordx4 v13, s[44:47], s64 offen lds
    s_add_u32 m0, m0, 1024
    s_add_u32 s64, s64, 1024
    v_xor_b32 v10, 16, v4
    buffer_load_dwordx4 v10, s[44:47], s64 offen lds
    s_add_u32 m0, m0, 1024
    s_add_u32 s64, s64, 1024
    v_xor_b32 v11, 80, v4
    buffer_load_dwordx4 v11, s[44:47], s64 offen lds
    s_add_u32 m0, m0, 1024
    s_add_u32 s64, s64, 1024
    v_xor_b32 v12, 144, v4
    buffer_load_dwordx4 v12, s[44:47], s64 offen lds
    s_add_u32 m0, m0, 1024
    s_add_u32 s64, s64, 1024
    v_xor_b32 v13, 208, v4
    buffer_load_dwordx4 v13, s[44:47], s64 offen lds
    s_add_u32 m0, m0, 1024
    s_add_u32 s64, s64, 1024
    v_xor_b32 v10, 32, v4
    buffer_load_dwordx4 v10, s[44:47], s64 offen lds
    s_add_u32 m0, m0, 1024
    s_add_u32 s64, s64, 1024
    v_xor_b32 v11, 96, v4
    buffer_load_dwordx4 v11, s[44:47], s64 offen lds
    s_add_u32 m0, m0, 1024
    s_add_u32 s64, s64, 1024
    v_xor_b32 v12, 160, v4
    buffer_load_dwordx4 v12, s[44:47], s64 offen lds
    s_add_u32 m0, m0, 1024
    s_add_u32 s64, s64, 1024
    v_xor_b32 v13, 224, v4
    buffer_load_dwordx4 v13, s[44:47], s64 offen lds
    s_add_u32 m0, m0, 1024
    s_add_u32 s64, s64, 1024
    v_xor_b32 v10, 48, v4
    buffer_load_dwordx4 v10, s[44:47], s64 offen lds
    s_add_u32 m0, m0, 1024
    s_add_u32 s64, s64, 1024
    v_xor_b32 v11, 112, v4
    buffer_load_dwordx4 v11, s[44:47], s64 offen lds
    s_add_u32 m0, m0, 1024
    s_add_u32 s64, s64, 1024
    v_xor_b32 v12, 176, v4
    buffer_load_dwordx4 v12, s[44:47], s64 offen lds
    s_add_u32 m0, m0, 1024
    s_add_u32 s64, s64, 1024
    v_xor_b32 v13, 240, v4
    buffer_load_dwordx4 v13, s[44:47], s64 offen lds
    s_add_u32 m0, m0, 1024
    s_add_u32 s64, s64, 1024
    v_xor_b32 v10, 0, v4
    buffer_load_dwordx4 v10, s[44:47], s64 offen lds
    s_add_u32 m0, m0, 1024
    s_add_u32 s64, s64, 1024
    v_xor_b32 v11, 64, v4
    buffer_load_dwordx4 v11, s[44:47], s64 offen lds
    s_add_u32 m0, m0, 1024
    s_add_u32 s64, s64, 1024
    v_xor_b32 v12, 128, v4
    buffer_load_dwordx4 v12, s[44:47], s64 offen lds
    s_add_u32 m0, m0, 1024
    s_add_u32 s64, s64, 1024
    v_xor_b32 v13, 192, v4
    buffer_load_dwordx4 v13, s[44:47], s64 offen lds
    s_add_u32 m0, m0, 1024
    s_add_u32 s64, s64, 1024
    v_xor_b32 v10, 16, v4
    buffer_load_dwordx4 v10, s[44:47], s64 offen lds
    s_add_u32 m0, m0, 1024
    s_add_u32 s64, s64, 1024
    v_xor_b32 v11, 80, v4
    buffer_load_dwordx4 v11, s[44:47], s64 offen lds
    s_add_u32 m0, m0, 1024
    s_add_u32 s64, s64, 1024
    v_xor_b32 v12, 144, v4
    buffer_load_dwordx4 v12, s[44:47], s64 offen lds
    s_add_u32 m0, m0, 1024
    s_add_u32 s64, s64, 1024
    v_xor_b32 v13, 208, v4
    buffer_load_dwordx4 v13, s[44:47], s64 offen lds
    s_add_u32 m0, m0, 1024
    s_add_u32 s64, s64, 1024
    v_xor_b32 v10, 32, v4
    buffer_load_dwordx4 v10, s[44:47], s64 offen lds
    s_add_u32 m0, m0, 1024
    s_add_u32 s64, s64, 1024
    v_xor_b32 v11, 96, v4
    buffer_load_dwordx4 v11, s[44:47], s64 offen lds
    s_add_u32 m0, m0, 1024
    s_add_u32 s64, s64, 1024
    v_xor_b32 v12, 160, v4
    buffer_load_dwordx4 v12, s[44:47], s64 offen lds
    s_add_u32 m0, m0, 1024
    s_add_u32 s64, s64, 1024
    v_xor_b32 v13, 224, v4
    buffer_load_dwordx4 v13, s[44:47], s64 offen lds
    s_add_u32 m0, m0, 1024
    s_add_u32 s64, s64, 1024
    v_xor_b32 v10, 48, v4
    buffer_load_dwordx4 v10, s[44:47], s64 offen lds
    s_add_u32 m0, m0, 1024
    s_add_u32 s64, s64, 1024
    v_xor_b32 v11, 112, v4
    buffer_load_dwordx4 v11, s[44:47], s64 offen lds
    s_add_u32 m0, m0, 1024
    s_add_u32 s64, s64, 1024
    v_xor_b32 v12, 176, v4
    buffer_load_dwordx4 v12, s[44:47], s64 offen lds
    s_add_u32 m0, m0, 1024
    s_add_u32 s64, s64, 1024
    v_xor_b32 v13, 240, v4
    buffer_load_dwordx4 v13, s[44:47], s64 offen lds
    v_and_b32 v27, 15, v8
    v_xor_b32 v27, v27, v9
    v_lshlrev_b32 v27, 4, v27
    v_lshl_add_u32 v27, v8, 10, v27
    v_add_u32 v27, 131072, v27
    v_xor_b32 v40, 0, v27
    v_xor_b32 v41, 32, v27
    v_xor_b32 v42, 64, v27
    v_xor_b32 v43, 96, v27
    v_xor_b32 v44, 128, v27
    v_xor_b32 v45, 160, v27
    v_xor_b32 v46, 192, v27
    v_xor_b32 v47, 224, v27
    v_and_b32 v11, 3, v8
    v_lshlrev_b32 v11, 2, v11
    v_bfe_u32 v12, v8, 2, 2
    v_or_b32 v11, v11, v12
    v_xor_b32 v11, v11, v9
    v_lshlrev_b32 v11, 4, v11
    v_lshl_add_u32 v11, v8, 10, v11
    v_add_u32 v11, s65, v11
    v_xor_b32 v48, 0, v11
    v_add_u32 v56, 0x10000, v48
    v_xor_b32 v49, 32, v11
    v_add_u32 v57, 0x10000, v49
    v_xor_b32 v50, 64, v11
    v_add_u32 v58, 0x10000, v50
    v_xor_b32 v51, 96, v11
    v_add_u32 v59, 0x10000, v51
    v_xor_b32 v52, 128, v11
    v_add_u32 v60, 0x10000, v52
    v_xor_b32 v53, 160, v11
    v_add_u32 v61, 0x10000, v53
    v_xor_b32 v54, 192, v11
    v_add_u32 v62, 0x10000, v54
    v_xor_b32 v55, 224, v11
    v_add_u32 v63, 0x10000, v55
    v_mov_b32 v20, 0
    v_mov_b32 v21, 0
    v_mov_b32 v22, 0
    v_mov_b32 v23, 0
    v_mov_b32 v24, 0
    v_mov_b32 v25, 0
    v_mov_b32 v26, 0
    v_mov_b32 v27, 0
    v_mov_b32 v28, 0
    v_mov_b32 v29, 0
    v_mov_b32 v30, 0
    v_mov_b32 v31, 0
    v_mov_b32 v32, 0
    v_mov_b32 v33, 0
    v_mov_b32 v34, 0
    v_mov_b32 v35, 0
    s_barrier
    ds_read_b128 v[64:67], v40 offset:0
    ds_read_b128 v[68:71], v41 offset:0
    ds_read_b128 v[72:75], v42 offset:0
    ds_read_b128 v[76:79], v43 offset:0
    ds_read_b128 v[80:83], v44 offset:0
    ds_read_b128 v[84:87], v45 offset:0
    ds_read_b128 v[88:91], v46 offset:0
    ds_read_b128 v[92:95], v47 offset:0
    ds_read_b128 v[96:99], v40 offset:256
    ds_read_b128 v[100:103], v41 offset:256
    ds_read_b128 v[104:107], v42 offset:256
    ds_read_b128 v[108:111], v43 offset:256
    ds_read_b128 v[112:115], v44 offset:256
    ds_read_b128 v[116:119], v45 offset:256
    ds_read_b128 v[120:123], v46 offset:256
    ds_read_b128 v[124:127], v47 offset:256
    s_waitcnt lgkmcnt(0)
    ds_read_b128 v[128:131], v40 offset:512
    ds_read_b128 v[132:135], v41 offset:512
    ds_read_b128 v[136:139], v42 offset:512
    ds_read_b128 v[140:143], v43 offset:512
    ds_read_b128 v[144:147], v44 offset:512
    ds_read_b128 v[148:151], v45 offset:512
    ds_read_b128 v[152:155], v46 offset:512
    ds_read_b128 v[156:159], v47 offset:512
    ds_read_b128 v[160:163], v40 offset:768
    ds_read_b128 v[164:167], v41 offset:768
    ds_read_b128 v[168:171], v42 offset:768
    ds_read_b128 v[172:175], v43 offset:768
    ds_read_b128 v[176:179], v44 offset:768
    ds_read_b128 v[180:183], v45 offset:768
    ds_read_b128 v[184:187], v46 offset:768
    ds_read_b128 v[188:191], v47 offset:768
    s_waitcnt lgkmcnt(0)
    s_barrier
    s_waitcnt vmcnt(0) lgkmcnt(0)
    ds_read_b128 v[192:195], v48 offset:0
    ds_read_b128 v[196:199], v49 offset:0
    ds_read_b128 v[200:203], v50 offset:0
    ds_read_b128 v[204:207], v51 offset:0
    ds_read_b128 v[208:211], v52 offset:0
    ds_read_b128 v[212:215], v53 offset:0
    ds_read_b128 v[216:219], v54 offset:0
    ds_read_b128 v[220:223], v55 offset:0
    s_waitcnt lgkmcnt(7)
    v_mfma_f32_32x32x16_bf16 v[20:35], v[192:195], v[64:67], v[20:35]
    s_waitcnt lgkmcnt(6)
    v_mfma_f32_32x32x16_bf16 v[20:35], v[196:199], v[68:71], v[20:35]
    s_waitcnt lgkmcnt(5)
    v_mfma_f32_32x32x16_bf16 v[20:35], v[200:203], v[72:75], v[20:35]
    s_waitcnt lgkmcnt(4)
    v_mfma_f32_32x32x16_bf16 v[20:35], v[204:207], v[76:79], v[20:35]
    s_waitcnt lgkmcnt(3)
    v_mfma_f32_32x32x16_bf16 v[20:35], v[208:211], v[80:83], v[20:35]
    s_waitcnt lgkmcnt(2)
    v_mfma_f32_32x32x16_bf16 v[20:35], v[212:215], v[84:87], v[20:35]
    s_waitcnt lgkmcnt(1)
    v_mfma_f32_32x32x16_bf16 v[20:35], v[216:219], v[88:91], v[20:35]
    s_waitcnt lgkmcnt(0)
    v_mfma_f32_32x32x16_bf16 v[20:35], v[220:223], v[92:95], v[20:35]
    ds_read_b128 v[192:195], v48 offset:256
    ds_read_b128 v[196:199], v49 offset:256
    ds_read_b128 v[200:203], v50 offset:256
    ds_read_b128 v[204:207], v51 offset:256
    ds_read_b128 v[208:211], v52 offset:256
    ds_read_b128 v[212:215], v53 offset:256
    ds_read_b128 v[216:219], v54 offset:256
    ds_read_b128 v[220:223], v55 offset:256
    s_waitcnt lgkmcnt(7)
    v_mfma_f32_32x32x16_bf16 v[20:35], v[192:195], v[96:99], v[20:35]
    s_waitcnt lgkmcnt(6)
    v_mfma_f32_32x32x16_bf16 v[20:35], v[196:199], v[100:103], v[20:35]
    s_waitcnt lgkmcnt(5)
    v_mfma_f32_32x32x16_bf16 v[20:35], v[200:203], v[104:107], v[20:35]
    s_waitcnt lgkmcnt(4)
    v_mfma_f32_32x32x16_bf16 v[20:35], v[204:207], v[108:111], v[20:35]
    s_waitcnt lgkmcnt(3)
    v_mfma_f32_32x32x16_bf16 v[20:35], v[208:211], v[112:115], v[20:35]
    s_waitcnt lgkmcnt(2)
    v_mfma_f32_32x32x16_bf16 v[20:35], v[212:215], v[116:119], v[20:35]
    s_waitcnt lgkmcnt(1)
    v_mfma_f32_32x32x16_bf16 v[20:35], v[216:219], v[120:123], v[20:35]
    s_waitcnt lgkmcnt(0)
    v_mfma_f32_32x32x16_bf16 v[20:35], v[220:223], v[124:127], v[20:35]
    ds_read_b128 v[192:195], v48 offset:512
    ds_read_b128 v[196:199], v49 offset:512
    ds_read_b128 v[200:203], v50 offset:512
    ds_read_b128 v[204:207], v51 offset:512
    ds_read_b128 v[208:211], v52 offset:512
    ds_read_b128 v[212:215], v53 offset:512
    ds_read_b128 v[216:219], v54 offset:512
    ds_read_b128 v[220:223], v55 offset:512
    s_waitcnt lgkmcnt(7)
    v_mfma_f32_32x32x16_bf16 v[20:35], v[192:195], v[128:131], v[20:35]
    s_waitcnt lgkmcnt(6)
    v_mfma_f32_32x32x16_bf16 v[20:35], v[196:199], v[132:135], v[20:35]
    s_waitcnt lgkmcnt(5)
    v_mfma_f32_32x32x16_bf16 v[20:35], v[200:203], v[136:139], v[20:35]
    s_waitcnt lgkmcnt(4)
    v_mfma_f32_32x32x16_bf16 v[20:35], v[204:207], v[140:143], v[20:35]
    s_waitcnt lgkmcnt(3)
    v_mfma_f32_32x32x16_bf16 v[20:35], v[208:211], v[144:147], v[20:35]
    s_waitcnt lgkmcnt(2)
    v_mfma_f32_32x32x16_bf16 v[20:35], v[212:215], v[148:151], v[20:35]
    s_waitcnt lgkmcnt(1)
    v_mfma_f32_32x32x16_bf16 v[20:35], v[216:219], v[152:155], v[20:35]
    s_waitcnt lgkmcnt(0)
    v_mfma_f32_32x32x16_bf16 v[20:35], v[220:223], v[156:159], v[20:35]
    ds_read_b128 v[192:195], v48 offset:768
    ds_read_b128 v[196:199], v49 offset:768
    ds_read_b128 v[200:203], v50 offset:768
    ds_read_b128 v[204:207], v51 offset:768
    ds_read_b128 v[208:211], v52 offset:768
    ds_read_b128 v[212:215], v53 offset:768
    ds_read_b128 v[216:219], v54 offset:768
    ds_read_b128 v[220:223], v55 offset:768
    s_waitcnt lgkmcnt(7)
    v_mfma_f32_32x32x16_bf16 v[20:35], v[192:195], v[160:163], v[20:35]
    s_waitcnt lgkmcnt(6)
    v_mfma_f32_32x32x16_bf16 v[20:35], v[196:199], v[164:167], v[20:35]
    s_waitcnt lgkmcnt(5)
    v_mfma_f32_32x32x16_bf16 v[20:35], v[200:203], v[168:171], v[20:35]
    s_waitcnt lgkmcnt(4)
    v_mfma_f32_32x32x16_bf16 v[20:35], v[204:207], v[172:175], v[20:35]
    s_waitcnt lgkmcnt(3)
    v_mfma_f32_32x32x16_bf16 v[20:35], v[208:211], v[176:179], v[20:35]
    s_waitcnt lgkmcnt(2)
    v_mfma_f32_32x32x16_bf16 v[20:35], v[212:215], v[180:183], v[20:35]
    s_waitcnt lgkmcnt(1)
    v_mfma_f32_32x32x16_bf16 v[20:35], v[216:219], v[184:187], v[20:35]
    s_waitcnt lgkmcnt(0)
    v_mfma_f32_32x32x16_bf16 v[20:35], v[220:223], v[188:191], v[20:35]
    v_lshlrev_b32 v38, 4, v8
    s_lshl_b32 s64, s19, 2
    s_add_u32 s64, s64, 139264
    v_add_u32 v39, s64, v38
    s_lshl_b32 s64, s19, 11
    s_add_u32 s64, s64, 131072
    v_add_u32 v42, s64, v4
    s_nop 7
    v_max3_f32 v36, v20, v21, v22
    v_max3_f32 v36, v36, v23, v24
    v_max3_f32 v36, v36, v25, v26
    v_max3_f32 v36, v36, v27, v28
    v_max3_f32 v36, v36, v29, v30
    v_max3_f32 v36, v36, v31, v32
    v_max3_f32 v36, v36, v33, v34
    v_max_f32 v36, v36, v35
    v_mov_b32 v37, v36
    s_nop 1
    v_permlane32_swap_b32 v36, v37
    s_nop 1
    v_max_f32 v36, v36, v37
    ds_write_b32 v39, v36
    s_waitcnt lgkmcnt(0)
    s_barrier
    v_add_u32 v40, 139264, v38
    ds_read_b128 v[44:47], v40
    s_mov_b32 s64, 0x3e0293ee
    s_waitcnt lgkmcnt(0)
    v_max3_f32 v36, v44, v45, v46
    v_max_f32 v36, v36, v47
    v_mul_f32 v36, s64, v36
    v_fma_f32 v20, v20, s64, -v36
    v_fma_f32 v21, v21, s64, -v36
    v_fma_f32 v22, v22, s64, -v36
    v_fma_f32 v23, v23, s64, -v36
    v_fma_f32 v24, v24, s64, -v36
    v_fma_f32 v25, v25, s64, -v36
    v_fma_f32 v26, v26, s64, -v36
    v_fma_f32 v27, v27, s64, -v36
    v_fma_f32 v28, v28, s64, -v36
    v_fma_f32 v29, v29, s64, -v36
    v_fma_f32 v30, v30, s64, -v36
    v_fma_f32 v31, v31, s64, -v36
    v_fma_f32 v32, v32, s64, -v36
    v_fma_f32 v33, v33, s64, -v36
    v_fma_f32 v34, v34, s64, -v36
    v_fma_f32 v35, v35, s64, -v36
    v_exp_f32 v20, v20
    v_exp_f32 v21, v21
    v_exp_f32 v22, v22
    v_exp_f32 v23, v23
    v_exp_f32 v24, v24
    v_exp_f32 v25, v25
    v_exp_f32 v26, v26
    v_exp_f32 v27, v27
    v_exp_f32 v28, v28
    v_exp_f32 v29, v29
    v_exp_f32 v30, v30
    v_exp_f32 v31, v31
    v_exp_f32 v32, v32
    v_exp_f32 v33, v33
    v_exp_f32 v34, v34
    v_exp_f32 v35, v35
    s_nop 0
    v_cvt_pk_bf16_f32 v48, v20, v21
    v_cvt_pk_bf16_f32 v49, v22, v23
    v_cvt_pk_bf16_f32 v50, v24, v25
    v_cvt_pk_bf16_f32 v51, v26, v27
    v_cvt_pk_bf16_f32 v52, v28, v29
    v_cvt_pk_bf16_f32 v53, v30, v31
    v_cvt_pk_bf16_f32 v54, v32, v33
    v_cvt_pk_bf16_f32 v55, v34, v35
    ds_write_b128 v42, v[48:51]
    ds_write_b128 v42, v[52:55] offset:1024
    v_add_f32 v37, v20, v21
    v_add_f32 v41, v22, v23
    v_add_f32 v43, v24, v25
    v_add_f32 v44, v26, v27
    v_add_f32 v37, v37, v28
    v_add_f32 v41, v41, v29
    v_add_f32 v43, v43, v30
    v_add_f32 v44, v44, v31
    v_add_f32 v37, v37, v32
    v_add_f32 v41, v41, v33
    v_add_f32 v43, v43, v34
    v_add_f32 v44, v44, v35
    v_add_f32 v37, v37, v41
    v_add_f32 v43, v43, v44
    v_add_f32 v37, v37, v43
    v_mov_b32 v41, v37
    s_nop 1
    v_permlane32_swap_b32 v37, v41
    s_nop 1
    v_add_f32 v37, v37, v41
    v_add_u32 v39, 512, v39
    ds_write_b32 v39, v37
    s_branch K2_PV
K2_B:
    s_lshl_b32 s64, s17, 15
    s_lshl_b32 s65, s19, 13
    s_add_u32 s64, s64, s65
    buffer_load_dwordx4 v[192:195], v4, s[40:43], s64 offen offset:0
    buffer_load_dwordx4 v[196:199], v4, s[40:43], s64 offen offset:1024
    buffer_load_dwordx4 v[200:203], v4, s[40:43], s64 offen offset:2048
    buffer_load_dwordx4 v[204:207], v4, s[40:43], s64 offen offset:3072
    s_add_u32 s64, s64, 4096
    buffer_load_dwordx4 v[208:211], v4, s[40:43], s64 offen offset:0
    buffer_load_dwordx4 v[212:215], v4, s[40:43], s64 offen offset:1024
    buffer_load_dwordx4 v[216:219], v4, s[40:43], s64 offen offset:2048
    buffer_load_dwordx4 v[220:223], v4, s[40:43], s64 offen offset:3072
    s_and_b32 s64, s19, 1
    s_lshl_b32 s64, s64, 7
    v_xor_b32 v26, s64, v4
    s_add_u32 s64, s65, 131072
    v_add_u32 v26, s64, v26
    v_xor_b32 v16, 0, v26
    v_xor_b32 v17, 16, v26
    v_xor_b32 v18, 32, v26
    v_xor_b32 v19, 48, v26
    v_xor_b32 v20, 64, v26
    v_xor_b32 v21, 80, v26
    v_xor_b32 v22, 96, v26
    v_xor_b32 v23, 112, v26
    v_lshlrev_b32 v38, 4, v8
    s_waitcnt vmcnt(0)
    ds_write_b128 v16, v[192:195] offset:0
    ds_write_b128 v17, v[196:199] offset:1024
    ds_write_b128 v18, v[200:203] offset:2048
    ds_write_b128 v19, v[204:207] offset:3072
    ds_write_b128 v20, v[208:211] offset:4096
    ds_write_b128 v21, v[212:215] offset:5120
    ds_write_b128 v22, v[216:219] offset:6144
    ds_write_b128 v23, v[220:223] offset:7168
    s_waitcnt lgkmcnt(0)
    s_barrier
    s_barrier
    v_and_b32 v56, 255, v0
    v_lshrrev_b32 v57, 4, v56
    v_lshlrev_b32 v56, 4, v56
    s_lshl_b32 s64, s16, 17
    s_lshl_b32 s65, s17, 14
    s_add_u32 s64, s64, s65
    buffer_load_dwordx4 v[240:243], v56, s[52:55], s64 offen
    s_add_u32 s64, s64, 4096
    buffer_load_dwordx4 v[244:247], v56, s[52:55], s64 offen
    s_add_u32 s64, s64, 4096
    buffer_load_dwordx4 v[248:251], v56, s[52:55], s64 offen
    s_add_u32 s64, s64, 4096
    buffer_load_dwordx4 v[252:255], v56, s[52:55], s64 offen
    s_add_u32 s64, s64, 4096
    v_lshlrev_b32 v57, 13, v57
    v_lshl_add_u32 v57, v3, 4, v57
    s_lshl_b32 s64, s17, 19
    s_lshl_b32 s65, s16, 8
    s_add_u32 s64, s64, s65
    buffer_load_dwordx4 v[240:243], v57, s[48:51], s64 offen
    s_add_u32 s64, s64, 131072
    buffer_load_dwordx4 v[244:247], v57, s[48:51], s64 offen
    s_add_u32 s64, s64, 131072
    buffer_load_dwordx4 v[248:251], v57, s[48:51], s64 offen
    s_add_u32 s64, s64, 131072
    buffer_load_dwordx4 v[252:255], v57, s[48:51], s64 offen
    s_add_u32 s64, s64, 131072
    s_lshl_b32 s64, s2, 14
    buffer_load_dwordx4 v[240:243], v56, s[56:59], s64 offen
    s_add_u32 s64, s64, 4096
    buffer_load_dwordx4 v[244:247], v56, s[56:59], s64 offen
    s_add_u32 s64, s64, 4096
    buffer_load_dwordx4 v[248:251], v56, s[56:59], s64 offen
    s_add_u32 s64, s64, 4096
    buffer_load_dwordx4 v[252:255], v56, s[56:59], s64 offen
    s_add_u32 s64, s64, 4096
    s_barrier
K2_PV:
    v_lshrrev_b32 v44, 2, v3
    v_bfe_u32 v45, v1, 4, 1
    v_lshl_add_u32 v46, v9, 2, v44
    v_bfe_u32 v47, v3, 1, 1
    v_lshl_add_u32 v47, v45, 1, v47
    v_lshl_add_u32 v56, v44, 2, v9
    v_xor_b32 v47, v47, v56
    v_lshlrev_b32 v47, 4, v47
    v_and_b32 v56, 1, v3
    v_lshl_add_u32 v47, v56, 3, v47
    v_lshl_add_u32 v47, v46, 10, v47
    s_lshr_b32 s64, s18, 1
    s_lshl_b32 s64, s64, 8
    v_add_u32 v47, s64, v47
    s_and_b32 s64, s18, 1
    s_lshl_b32 s64, s64, 7
    v_xor_b32 v47, s64, v47
    v_xor_b32 v224, 0, v47
    v_add_u32 v228, 0x10000, v224
    v_xor_b32 v225, 32, v47
    v_add_u32 v225, 8192, v225
    v_add_u32 v229, 0x10000, v225
    v_xor_b32 v226, 64, v47
    v_add_u32 v230, 0x10000, v226
    v_xor_b32 v227, 96, v47
    v_add_u32 v227, 8192, v227
    v_add_u32 v231, 0x10000, v227
    v_add_u32 v42, 131072, v4
    v_add_u32 v40, 139776, v38
    v_mov_b32 v128, 0
    v_mov_b32 v129, 0
    v_mov_b32 v130, 0
    v_mov_b32 v131, 0
    v_mov_b32 v132, 0
    v_mov_b32 v133, 0
    v_mov_b32 v134, 0
    v_mov_b32 v135, 0
    v_mov_b32 v136, 0
    v_mov_b32 v137, 0
    v_mov_b32 v138, 0
    v_mov_b32 v139, 0
    v_mov_b32 v140, 0
    v_mov_b32 v141, 0
    v_mov_b32 v142, 0
    v_mov_b32 v143, 0
    v_mov_b32 v144, 0
    v_mov_b32 v145, 0
    v_mov_b32 v146, 0
    v_mov_b32 v147, 0
    v_mov_b32 v148, 0
    v_mov_b32 v149, 0
    v_mov_b32 v150, 0
    v_mov_b32 v151, 0
    v_mov_b32 v152, 0
    v_mov_b32 v153, 0
    v_mov_b32 v154, 0
    v_mov_b32 v155, 0
    v_mov_b32 v156, 0
    v_mov_b32 v157, 0
    v_mov_b32 v158, 0
    v_mov_b32 v159, 0
    v_and_b32 v60, 7, v8
    v_lshlrev_b32 v60, 4, v60
    v_lshl_add_u32 v60, v9, 3, v60
    v_lshl_add_u32 v60, v8, 7, v60
    s_lshl_b32 s64, s18, 12
    v_add_u32 v60, s64, v60
    v_lshrrev_b32 v61, 3, v1
    v_and_b32 v62, 7, v1
    v_xor_b32 v63, v61, v62
    v_lshlrev_b32 v63, 4, v63
    v_lshl_add_u32 v63, v61, 7, v63
    v_add_u32 v63, s64, v63
    v_lshlrev_b32 v61, 18, v61
    v_lshl_add_u32 v61, v62, 4, v61
    s_lshl_b32 s68, s2, 7
    s_lshl_b32 s65, s18, 15
    s_add_u32 s68, s68, s65
    s_add_u32 s68, s68, 1048576
    s_waitcnt lgkmcnt(0)
    s_barrier
    ds_read_b128 v[96:99], v42 offset:0
    ds_read_b128 v[100:103], v42 offset:1024
    ds_read_b128 v[104:107], v42 offset:2048
    ds_read_b128 v[108:111], v42 offset:3072
    ds_read_b128 v[112:115], v42 offset:4096
    ds_read_b128 v[116:119], v42 offset:5120
    ds_read_b128 v[120:123], v42 offset:6144
    ds_read_b128 v[124:127], v42 offset:7168
    ds_read_b128 v[44:47], v40
    ds_read_b64_tr_b16 v[192:193], v224 offset:0
    ds_read_b64_tr_b16 v[194:195], v225 offset:0
    ds_read_b64_tr_b16 v[196:197], v226 offset:0
    ds_read_b64_tr_b16 v[198:199], v227 offset:0
    ds_read_b64_tr_b16 v[200:201], v224 offset:16384
    ds_read_b64_tr_b16 v[202:203], v225 offset:16384
    ds_read_b64_tr_b16 v[204:205], v226 offset:16384
    ds_read_b64_tr_b16 v[206:207], v227 offset:16384
    s_waitcnt lgkmcnt(6)
    v_mfma_f32_32x32x16_bf16 v[128:143], v[192:195], v[96:99], v[128:143]
    s_waitcnt lgkmcnt(4)
    v_mfma_f32_32x32x16_bf16 v[144:159], v[196:199], v[96:99], v[144:159]
    s_waitcnt lgkmcnt(2)
    v_mfma_f32_32x32x16_bf16 v[128:143], v[200:203], v[100:103], v[128:143]
    s_waitcnt lgkmcnt(0)
    v_mfma_f32_32x32x16_bf16 v[144:159], v[204:207], v[100:103], v[144:159]
    ds_read_b64_tr_b16 v[192:193], v224 offset:32768
    ds_read_b64_tr_b16 v[194:195], v225 offset:32768
    ds_read_b64_tr_b16 v[196:197], v226 offset:32768
    ds_read_b64_tr_b16 v[198:199], v227 offset:32768
    ds_read_b64_tr_b16 v[200:201], v224 offset:49152
    ds_read_b64_tr_b16 v[202:203], v225 offset:49152
    ds_read_b64_tr_b16 v[204:205], v226 offset:49152
    ds_read_b64_tr_b16 v[206:207], v227 offset:49152
    s_waitcnt lgkmcnt(6)
    v_mfma_f32_32x32x16_bf16 v[128:143], v[192:195], v[104:107], v[128:143]
    s_waitcnt lgkmcnt(4)
    v_mfma_f32_32x32x16_bf16 v[144:159], v[196:199], v[104:107], v[144:159]
    s_waitcnt lgkmcnt(2)
    v_mfma_f32_32x32x16_bf16 v[128:143], v[200:203], v[108:111], v[128:143]
    s_waitcnt lgkmcnt(0)
    v_mfma_f32_32x32x16_bf16 v[144:159], v[204:207], v[108:111], v[144:159]
    ds_read_b64_tr_b16 v[192:193], v228 offset:0
    ds_read_b64_tr_b16 v[194:195], v229 offset:0
    ds_read_b64_tr_b16 v[196:197], v230 offset:0
    ds_read_b64_tr_b16 v[198:199], v231 offset:0
    ds_read_b64_tr_b16 v[200:201], v228 offset:16384
    ds_read_b64_tr_b16 v[202:203], v229 offset:16384
    ds_read_b64_tr_b16 v[204:205], v230 offset:16384
    ds_read_b64_tr_b16 v[206:207], v231 offset:16384
    s_waitcnt lgkmcnt(6)
    v_mfma_f32_32x32x16_bf16 v[128:143], v[192:195], v[112:115], v[128:143]
    s_waitcnt lgkmcnt(4)
    v_mfma_f32_32x32x16_bf16 v[144:159], v[196:199], v[112:115], v[144:159]
    s_waitcnt lgkmcnt(2)
    v_mfma_f32_32x32x16_bf16 v[128:143], v[200:203], v[116:119], v[128:143]
    s_waitcnt lgkmcnt(0)
    v_mfma_f32_32x32x16_bf16 v[144:159], v[204:207], v[116:119], v[144:159]
    ds_read_b64_tr_b16 v[192:193], v228 offset:32768
    ds_read_b64_tr_b16 v[194:195], v229 offset:32768
    ds_read_b64_tr_b16 v[196:197], v230 offset:32768
    ds_read_b64_tr_b16 v[198:199], v231 offset:32768
    ds_read_b64_tr_b16 v[200:201], v228 offset:49152
    ds_read_b64_tr_b16 v[202:203], v229 offset:49152
    ds_read_b64_tr_b16 v[204:205], v230 offset:49152
    ds_read_b64_tr_b16 v[206:207], v231 offset:49152
    s_waitcnt lgkmcnt(6)
    v_mfma_f32_32x32x16_bf16 v[128:143], v[192:195], v[120:123], v[128:143]
    s_waitcnt lgkmcnt(4)
    v_mfma_f32_32x32x16_bf16 v[144:159], v[196:199], v[120:123], v[144:159]
    s_waitcnt lgkmcnt(2)
    v_mfma_f32_32x32x16_bf16 v[128:143], v[200:203], v[124:127], v[128:143]
    s_waitcnt lgkmcnt(0)
    v_mfma_f32_32x32x16_bf16 v[144:159], v[204:207], v[124:127], v[144:159]
    s_cmp_lg_u32 s18, 0
    s_cbranch_scc1 K2_NOSTAT
    v_add_f32 v37, v44, v45
    v_add_f32 v46, v46, v47
    v_add_f32 v37, v37, v46
    v_lshlrev_b32 v40, 11, v8
    v_cmp_lt_u32 vcc, 0, v9
    v_mov_b32 v41, 0x7f000000
    s_lshl_b32 s64, s2, 3
    s_add_u32 s64, s64, 327680
    v_cndmask_b32 v40, v40, v41, vcc
    buffer_store_dwordx2 v[36:37], v40, s[40:43], s64 offen
K2_NOSTAT:
    s_nop 7
    s_nop 3
    v_cvt_pk_bf16_f32 v160, v128, v129
    v_cvt_pk_bf16_f32 v161, v130, v131
    v_xor_b32 v176, 0, v60
    v_cvt_pk_bf16_f32 v162, v132, v133
    v_cvt_pk_bf16_f32 v163, v134, v135
    v_xor_b32 v177, 16, v60
    v_cvt_pk_bf16_f32 v164, v136, v137
    v_cvt_pk_bf16_f32 v165, v138, v139
    v_xor_b32 v178, 32, v60
    v_cvt_pk_bf16_f32 v166, v140, v141
    v_cvt_pk_bf16_f32 v167, v142, v143
    v_xor_b32 v179, 48, v60
    v_cvt_pk_bf16_f32 v168, v144, v145
    v_cvt_pk_bf16_f32 v169, v146, v147
    v_xor_b32 v180, 64, v60
    v_cvt_pk_bf16_f32 v170, v148, v149
    v_cvt_pk_bf16_f32 v171, v150, v151
    v_xor_b32 v181, 80, v60
    v_cvt_pk_bf16_f32 v172, v152, v153
    v_cvt_pk_bf16_f32 v173, v154, v155
    v_xor_b32 v182, 96, v60
    v_cvt_pk_bf16_f32 v174, v156, v157
    v_cvt_pk_bf16_f32 v175, v158, v159
    v_xor_b32 v183, 112, v60
    s_barrier
    ds_write_b64 v176, v[160:161]
    ds_write_b64 v177, v[162:163]
    ds_write_b64 v178, v[164:165]
    ds_write_b64 v179, v[166:167]
    ds_write_b64 v180, v[168:169]
    ds_write_b64 v181, v[170:171]
    ds_write_b64 v182, v[172:173]
    ds_write_b64 v183, v[174:175]
    ds_read_b128 v[64:67], v63 offset:0
    ds_read_b128 v[68:71], v63 offset:1024
    ds_read_b128 v[72:75], v63 offset:2048
    ds_read_b128 v[76:79], v63 offset:3072
    s_waitcnt lgkmcnt(3)
    buffer_store_dwordx4 v[64:67], v61, s[40:43], s68 offen sc1
    s_add_u32 s68, s68, 2097152
    s_waitcnt lgkmcnt(2)
    buffer_store_dwordx4 v[68:71], v61, s[40:43], s68 offen sc1
    s_add_u32 s68, s68, 2097152
    s_waitcnt lgkmcnt(1)
    buffer_store_dwordx4 v[72:75], v61, s[40:43], s68 offen sc1
    s_add_u32 s68, s68, 2097152
    s_waitcnt lgkmcnt(0)
    buffer_store_dwordx4 v[76:79], v61, s[40:43], s68 offen sc1
K2_END:
    s_endpgm
.globl k3_kernel
.p2align 8
.type k3_kernel,@function
k3_kernel:
    s_cmp_ge_u32 s2, 256
    s_cbranch_scc1 K3_END
    s_load_dwordx4 s[12:15], s[0:1], 32
    s_load_dwordx2 s[72:73], s[0:1], 72
    s_load_dwordx2 s[78:79], s[0:1], 96
    s_and_b32 s16, s2, 31
    s_lshr_b32 s17, s2, 5
    v_lshrrev_b32 v2, 6, v0
    v_and_b32 v1, 63, v0
    s_nop 0
    v_readfirstlane_b32 s18, v2
    v_lshrrev_b32 v2, 4, v1
    v_and_b32 v3, 15, v1
    s_mov_b32 s19, s18
    s_and_b32 s19, s18, 3
    s_and_b32 s17, s17, 3
    s_lshr_b32 s20, s2, 7
    s_and_b32 s21, s2, 127
    s_waitcnt lgkmcnt(0)
    s_mov_b32 s40, s78
    s_and_b32 s41, s79, 0xffff
    s_mov_b32 s42, 23068672
    s_mov_b32 s43, 0x00020000
    s_mov_b32 s48, s12
    s_and_b32 s49, s13, 0xffff
    s_mov_b32 s50, 4194304
    s_mov_b32 s51, 0x00020000
    s_mov_b32 s52, s14
    s_and_b32 s53, s15, 0xffff
    s_mov_b32 s54, 4194304
    s_mov_b32 s55, 0x00020000
    s_mov_b32 s56, s72
    s_and_b32 s57, s73, 0xffff
    s_mov_b32 s58, 1409024
    s_mov_b32 s59, 0x00020000
    v_lshlrev_b32 v4, 4, v1
    v_and_b32 v48, 7, v1
    v_mul_u32_u24 v18, 2752, v48
    v_lshl_add_u32 v18, v2, 3, v18
    s_lshl_b32 s64, s21, 5
    s_add_u32 s64, s64, 262144
    s_cmp_ge_u32 s18, 4
    s_cbranch_scc1 K3_B
    v_lshlrev_b32 v5, 3, v0
    s_lshl_b32 s65, s16, 11
    s_add_u32 s65, s65, 327680
    buffer_load_dwordx2 v[8:9], v5, s[40:43], s65 offen
    v_lshrrev_b32 v6, 4, v0
    v_lshlrev_b32 v7, 6, v6
    v_lshlrev_b32 v6, 11, v6
    v_lshl_add_u32 v6, v48, 4, v6
    v_lshrrev_b32 v10, 3, v3
    v_lshl_add_u32 v6, v10, 15, v6
    s_lshl_b32 s65, s16, 2
    s_add_u32 s65, s65, s17
    s_lshl_b32 s65, s65, 16
    s_add_u32 s65, s65, 1048576
    buffer_load_dwordx4 v[64:67], v6, s[40:43], s65 offen offset:0
    buffer_load_dwordx4 v[68:71], v6, s[40:43], s65 offen offset:128
    buffer_load_dwordx4 v[72:75], v6, s[40:43], s65 offen offset:256
    buffer_load_dwordx4 v[76:79], v6, s[40:43], s65 offen offset:384
    buffer_load_dwordx4 v[80:83], v6, s[40:43], s65 offen offset:512
    buffer_load_dwordx4 v[84:87], v6, s[40:43], s65 offen offset:640
    buffer_load_dwordx4 v[88:91], v6, s[40:43], s65 offen offset:768
    buffer_load_dwordx4 v[92:95], v6, s[40:43], s65 offen offset:896
    buffer_load_dwordx4 v[96:99], v6, s[40:43], s65 offen offset:1024
    buffer_load_dwordx4 v[100:103], v6, s[40:43], s65 offen offset:1152
    buffer_load_dwordx4 v[104:107], v6, s[40:43], s65 offen offset:1280
    buffer_load_dwordx4 v[108:111], v6, s[40:43], s65 offen offset:1408
    buffer_load_dwordx4 v[112:115], v6, s[40:43], s65 offen offset:1536
    buffer_load_dwordx4 v[116:119], v6, s[40:43], s65 offen offset:1664
    buffer_load_dwordx4 v[120:123], v6, s[40:43], s65 offen offset:1792
    buffer_load_dwordx4 v[124:127], v6, s[40:43], s65 offen offset:1920
    buffer_load_dwordx2 v[144:145], v18, s[40:43], s64 offen
    s_waitcnt vmcnt(17)
    v_mov_b32 v20, v8
    s_nop 1
    v_max_f32_dpp v20, v20, v20 quad_perm:[1,0,3,2] row_mask:0xf bank_mask:0xf
    s_nop 1
    v_max_f32_dpp v20, v20, v20 quad_perm:[2,3,0,1] row_mask:0xf bank_mask:0xf
    s_nop 1
    v_max_f32_dpp v20, v20, v20 row_half_mirror row_mask:0xf bank_mask:0xf
    s_nop 1
    v_max_f32_dpp v20, v20, v20 row_mirror row_mask:0xf bank_mask:0xf
    v_mov_b32 v21, v20
    s_nop 1
    v_permlane16_swap_b32 v20, v21
    s_nop 1
    v_max_f32 v20, v20, v21
    v_sub_f32 v20, v8, v20
    v_exp_f32 v20, v20
    s_nop 0
    v_mul_f32 v22, v20, v9
    s_nop 1
    v_add_f32_dpp v22, v22, v22 quad_perm:[1,0,3,2] row_mask:0xf bank_mask:0xf
    s_nop 1
    v_add_f32_dpp v22, v22, v22 quad_perm:[2,3,0,1] row_mask:0xf bank_mask:0xf
    s_nop 1
    v_add_f32_dpp v22, v22, v22 row_half_mirror row_mask:0xf bank_mask:0xf
    s_nop 1
    v_add_f32_dpp v22, v22, v22 row_mirror row_mask:0xf bank_mask:0xf
    v_mov_b32 v21, v22
    s_nop 1
    v_permlane16_swap_b32 v22, v21
    s_nop 1
    v_add_f32 v22, v22, v21
    v_rcp_f32 v22, v22
    s_nop 0
    v_mul_f32 v20, v20, v22
    v_lshlrev_b32 v21, 2, v0
    v_add_u32 v21, 98304, v21
    ds_write_b32 v21, v20
    v_add_u32 v7, 98304, v7
    ds_read_b128 v[24:27], v7 offset:0
    ds_read_b128 v[28:31], v7 offset:16
    ds_read_b128 v[32:35], v7 offset:32
    ds_read_b128 v[36:39], v7 offset:48
    v_mov_b32 v40, 0
    v_mov_b32 v41, 0
    v_mov_b32 v42, 0
    v_mov_b32 v43, 0
    v_mov_b32 v44, 0
    v_mov_b32 v45, 0
    v_mov_b32 v46, 0
    v_mov_b32 v47, 0
    s_waitcnt lgkmcnt(0)
    s_waitcnt vmcnt(16)
    v_lshlrev_b32 v56, 16, v64
    v_and_b32 v57, 0xffff0000, v64
    v_fmac_f32 v40, v24, v56
    v_fmac_f32 v41, v24, v57
    v_lshlrev_b32 v56, 16, v65
    v_and_b32 v57, 0xffff0000, v65
    v_fmac_f32 v42, v24, v56
    v_fmac_f32 v43, v24, v57
    v_lshlrev_b32 v56, 16, v66
    v_and_b32 v57, 0xffff0000, v66
    v_fmac_f32 v44, v24, v56
    v_fmac_f32 v45, v24, v57
    v_lshlrev_b32 v56, 16, v67
    v_and_b32 v57, 0xffff0000, v67
    v_fmac_f32 v46, v24, v56
    v_fmac_f32 v47, v24, v57
    s_waitcnt vmcnt(15)
    v_lshlrev_b32 v56, 16, v68
    v_and_b32 v57, 0xffff0000, v68
    v_fmac_f32 v40, v25, v56
    v_fmac_f32 v41, v25, v57
    v_lshlrev_b32 v56, 16, v69
    v_and_b32 v57, 0xffff0000, v69
    v_fmac_f32 v42, v25, v56
    v_fmac_f32 v43, v25, v57
    v_lshlrev_b32 v56, 16, v70
    v_and_b32 v57, 0xffff0000, v70
    v_fmac_f32 v44, v25, v56
    v_fmac_f32 v45, v25, v57
    v_lshlrev_b32 v56, 16, v71
    v_and_b32 v57, 0xffff0000, v71
    v_fmac_f32 v46, v25, v56
    v_fmac_f32 v47, v25, v57
    s_waitcnt vmcnt(14)
    v_lshlrev_b32 v56, 16, v72
    v_and_b32 v57, 0xffff0000, v72
    v_fmac_f32 v40, v26, v56
    v_fmac_f32 v41, v26, v57
    v_lshlrev_b32 v56, 16, v73
    v_and_b32 v57, 0xffff0000, v73
    v_fmac_f32 v42, v26, v56
    v_fmac_f32 v43, v26, v57
    v_lshlrev_b32 v56, 16, v74
    v_and_b32 v57, 0xffff0000, v74
    v_fmac_f32 v44, v26, v56
    v_fmac_f32 v45, v26, v57
    v_lshlrev_b32 v56, 16, v75
    v_and_b32 v57, 0xffff0000, v75
    v_fmac_f32 v46, v26, v56
    v_fmac_f32 v47, v26, v57
    s_waitcnt vmcnt(13)
    v_lshlrev_b32 v56, 16, v76
    v_and_b32 v57, 0xffff0000, v76
    v_fmac_f32 v40, v27, v56
    v_fmac_f32 v41, v27, v57
    v_lshlrev_b32 v56, 16, v77
    v_and_b32 v57, 0xffff0000, v77
    v_fmac_f32 v42, v27, v56
    v_fmac_f32 v43, v27, v57
    v_lshlrev_b32 v56, 16, v78
    v_and_b32 v57, 0xffff0000, v78
    v_fmac_f32 v44, v27, v56
    v_fmac_f32 v45, v27, v57
    v_lshlrev_b32 v56, 16, v79
    v_and_b32 v57, 0xffff0000, v79
    v_fmac_f32 v46, v27, v56
    v_fmac_f32 v47, v27, v57
    s_waitcnt vmcnt(12)
    v_lshlrev_b32 v56, 16, v80
    v_and_b32 v57, 0xffff0000, v80
    v_fmac_f32 v40, v28, v56
    v_fmac_f32 v41, v28, v57
    v_lshlrev_b32 v56, 16, v81
    v_and_b32 v57, 0xffff0000, v81
    v_fmac_f32 v42, v28, v56
    v_fmac_f32 v43, v28, v57
    v_lshlrev_b32 v56, 16, v82
    v_and_b32 v57, 0xffff0000, v82
    v_fmac_f32 v44, v28, v56
    v_fmac_f32 v45, v28, v57
    v_lshlrev_b32 v56, 16, v83
    v_and_b32 v57, 0xffff0000, v83
    v_fmac_f32 v46, v28, v56
    v_fmac_f32 v47, v28, v57
    s_waitcnt vmcnt(11)
    v_lshlrev_b32 v56, 16, v84
    v_and_b32 v57, 0xffff0000, v84
    v_fmac_f32 v40, v29, v56
    v_fmac_f32 v41, v29, v57
    v_lshlrev_b32 v56, 16, v85
    v_and_b32 v57, 0xffff0000, v85
    v_fmac_f32 v42, v29, v56
    v_fmac_f32 v43, v29, v57
    v_lshlrev_b32 v56, 16, v86
    v_and_b32 v57, 0xffff0000, v86
    v_fmac_f32 v44, v29, v56
    v_fmac_f32 v45, v29, v57
    v_lshlrev_b32 v56, 16, v87
    v_and_b32 v57, 0xffff0000, v87
    v_fmac_f32 v46, v29, v56
    v_fmac_f32 v47, v29, v57
    s_waitcnt vmcnt(10)
    v_lshlrev_b32 v56, 16, v88
    v_and_b32 v57, 0xffff0000, v88
    v_fmac_f32 v40, v30, v56
    v_fmac_f32 v41, v30, v57
    v_lshlrev_b32 v56, 16, v89
    v_and_b32 v57, 0xffff0000, v89
    v_fmac_f32 v42, v30, v56
    v_fmac_f32 v43, v30, v57
    v_lshlrev_b32 v56, 16, v90
    v_and_b32 v57, 0xffff0000, v90
    v_fmac_f32 v44, v30, v56
    v_fmac_f32 v45, v30, v57
    v_lshlrev_b32 v56, 16, v91
    v_and_b32 v57, 0xffff0000, v91
    v_fmac_f32 v46, v30, v56
    v_fmac_f32 v47, v30, v57
    s_waitcnt vmcnt(9)
    v_lshlrev_b32 v56, 16, v92
    v_and_b32 v57, 0xffff0000, v92
    v_fmac_f32 v40, v31, v56
    v_fmac_f32 v41, v31, v57
    v_lshlrev_b32 v56, 16, v93
    v_and_b32 v57, 0xffff0000, v93
    v_fmac_f32 v42, v31, v56
    v_fmac_f32 v43, v31, v57
    v_lshlrev_b32 v56, 16, v94
    v_and_b32 v57, 0xffff0000, v94
    v_fmac_f32 v44, v31, v56
    v_fmac_f32 v45, v31, v57
    v_lshlrev_b32 v56, 16, v95
    v_and_b32 v57, 0xffff0000, v95
    v_fmac_f32 v46, v31, v56
    v_fmac_f32 v47, v31, v57
    s_waitcnt vmcnt(8)
    v_lshlrev_b32 v56, 16, v96
    v_and_b32 v57, 0xffff0000, v96
    v_fmac_f32 v40, v32, v56
    v_fmac_f32 v41, v32, v57
    v_lshlrev_b32 v56, 16, v97
    v_and_b32 v57, 0xffff0000, v97
    v_fmac_f32 v42, v32, v56
    v_fmac_f32 v43, v32, v57
    v_lshlrev_b32 v56, 16, v98
    v_and_b32 v57, 0xffff0000, v98
    v_fmac_f32 v44, v32, v56
    v_fmac_f32 v45, v32, v57
    v_lshlrev_b32 v56, 16, v99
    v_and_b32 v57, 0xffff0000, v99
    v_fmac_f32 v46, v32, v56
    v_fmac_f32 v47, v32, v57
    s_waitcnt vmcnt(7)
    v_lshlrev_b32 v56, 16, v100
    v_and_b32 v57, 0xffff0000, v100
    v_fmac_f32 v40, v33, v56
    v_fmac_f32 v41, v33, v57
    v_lshlrev_b32 v56, 16, v101
    v_and_b32 v57, 0xffff0000, v101
    v_fmac_f32 v42, v33, v56
    v_fmac_f32 v43, v33, v57
    v_lshlrev_b32 v56, 16, v102
    v_and_b32 v57, 0xffff0000, v102
    v_fmac_f32 v44, v33, v56
    v_fmac_f32 v45, v33, v57
    v_lshlrev_b32 v56, 16, v103
    v_and_b32 v57, 0xffff0000, v103
    v_fmac_f32 v46, v33, v56
    v_fmac_f32 v47, v33, v57
    s_waitcnt vmcnt(6)
    v_lshlrev_b32 v56, 16, v104
    v_and_b32 v57, 0xffff0000, v104
    v_fmac_f32 v40, v34, v56
    v_fmac_f32 v41, v34, v57
    v_lshlrev_b32 v56, 16, v105
    v_and_b32 v57, 0xffff0000, v105
    v_fmac_f32 v42, v34, v56
    v_fmac_f32 v43, v34, v57
    v_lshlrev_b32 v56, 16, v106
    v_and_b32 v57, 0xffff0000, v106
    v_fmac_f32 v44, v34, v56
    v_fmac_f32 v45, v34, v57
    v_lshlrev_b32 v56, 16, v107
    v_and_b32 v57, 0xffff0000, v107
    v_fmac_f32 v46, v34, v56
    v_fmac_f32 v47, v34, v57
    s_waitcnt vmcnt(5)
    v_lshlrev_b32 v56, 16, v108
    v_and_b32 v57, 0xffff0000, v108
    v_fmac_f32 v40, v35, v56
    v_fmac_f32 v41, v35, v57
    v_lshlrev_b32 v56, 16, v109
    v_and_b32 v57, 0xffff0000, v109
    v_fmac_f32 v42, v35, v56
    v_fmac_f32 v43, v35, v57
    v_lshlrev_b32 v56, 16, v110
    v_and_b32 v57, 0xffff0000, v110
    v_fmac_f32 v44, v35, v56
    v_fmac_f32 v45, v35, v57
    v_lshlrev_b32 v56, 16, v111
    v_and_b32 v57, 0xffff0000, v111
    v_fmac_f32 v46, v35, v56
    v_fmac_f32 v47, v35, v57
    s_waitcnt vmcnt(4)
    v_lshlrev_b32 v56, 16, v112
    v_and_b32 v57, 0xffff0000, v112
    v_fmac_f32 v40, v36, v56
    v_fmac_f32 v41, v36, v57
    v_lshlrev_b32 v56, 16, v113
    v_and_b32 v57, 0xffff0000, v113
    v_fmac_f32 v42, v36, v56
    v_fmac_f32 v43, v36, v57
    v_lshlrev_b32 v56, 16, v114
    v_and_b32 v57, 0xffff0000, v114
    v_fmac_f32 v44, v36, v56
    v_fmac_f32 v45, v36, v57
    v_lshlrev_b32 v56, 16, v115
    v_and_b32 v57, 0xffff0000, v115
    v_fmac_f32 v46, v36, v56
    v_fmac_f32 v47, v36, v57
    s_waitcnt vmcnt(3)
    v_lshlrev_b32 v56, 16, v116
    v_and_b32 v57, 0xffff0000, v116
    v_fmac_f32 v40, v37, v56
    v_fmac_f32 v41, v37, v57
    v_lshlrev_b32 v56, 16, v117
    v_and_b32 v57, 0xffff0000, v117
    v_fmac_f32 v42, v37, v56
    v_fmac_f32 v43, v37, v57
    v_lshlrev_b32 v56, 16, v118
    v_and_b32 v57, 0xffff0000, v118
    v_fmac_f32 v44, v37, v56
    v_fmac_f32 v45, v37, v57
    v_lshlrev_b32 v56, 16, v119
    v_and_b32 v57, 0xffff0000, v119
    v_fmac_f32 v46, v37, v56
    v_fmac_f32 v47, v37, v57
    s_waitcnt vmcnt(2)
    v_lshlrev_b32 v56, 16, v120
    v_and_b32 v57, 0xffff0000, v120
    v_fmac_f32 v40, v38, v56
    v_fmac_f32 v41, v38, v57
    v_lshlrev_b32 v56, 16, v121
    v_and_b32 v57, 0xffff0000, v121
    v_fmac_f32 v42, v38, v56
    v_fmac_f32 v43, v38, v57
    v_lshlrev_b32 v56, 16, v122
    v_and_b32 v57, 0xffff0000, v122
    v_fmac_f32 v44, v38, v56
    v_fmac_f32 v45, v38, v57
    v_lshlrev_b32 v56, 16, v123
    v_and_b32 v57, 0xffff0000, v123
    v_fmac_f32 v46, v38, v56
    v_fmac_f32 v47, v38, v57
    s_waitcnt vmcnt(1)
    v_lshlrev_b32 v56, 16, v124
    v_and_b32 v57, 0xffff0000, v124
    v_fmac_f32 v40, v39, v56
    v_fmac_f32 v41, v39, v57
    v_lshlrev_b32 v56, 16, v125
    v_and_b32 v57, 0xffff0000, v125
    v_fmac_f32 v42, v39, v56
    v_fmac_f32 v43, v39, v57
    v_lshlrev_b32 v56, 16, v126
    v_and_b32 v57, 0xffff0000, v126
    v_fmac_f32 v44, v39, v56
    v_fmac_f32 v45, v39, v57
    v_lshlrev_b32 v56, 16, v127
    v_and_b32 v57, 0xffff0000, v127
    v_fmac_f32 v46, v39, v56
    v_fmac_f32 v47, v39, v57
    v_mov_b32 v56, v40
    v_mov_b32 v57, v41
    v_mov_b32 v58, v42
    v_mov_b32 v59, v43
    v_mov_b32 v60, v44
    v_mov_b32 v61, v45
    v_mov_b32 v62, v46
    v_mov_b32 v63, v47
    s_nop 1
    v_permlane16_swap_b32 v40, v56
    v_permlane16_swap_b32 v41, v57
    v_permlane16_swap_b32 v42, v58
    v_permlane16_swap_b32 v43, v59
    v_permlane16_swap_b32 v44, v60
    v_permlane16_swap_b32 v45, v61
    v_permlane16_swap_b32 v46, v62
    v_permlane16_swap_b32 v47, v63
    s_nop 1
    v_add_f32 v40, v40, v56
    v_add_f32 v41, v41, v57
    v_add_f32 v42, v42, v58
    v_add_f32 v43, v43, v59
    v_add_f32 v44, v44, v60
    v_add_f32 v45, v45, v61
    v_add_f32 v46, v46, v62
    v_add_f32 v47, v47, v63
    v_cvt_pk_bf16_f32 v56, v40, v41
    v_cvt_pk_bf16_f32 v57, v42, v43
    v_cvt_pk_bf16_f32 v58, v44, v45
    v_cvt_pk_bf16_f32 v59, v46, v47
    v_lshrrev_b32 v49, 5, v0
    v_mul_u32_u24 v49, 272, v49
    v_lshl_add_u32 v49, v3, 4, v49
    v_add_u32 v49, 99328, v49
    ds_write_b128 v49, v[56:59]
    v_mul_u32_u24 v49, 272, v48
    v_lshl_add_u32 v49, v2, 3, v49
    v_add_u32 v49, 99328, v49
    v_lshrrev_b32 v50, 2, v3
    v_lshl_add_u32 v51, v2, 2, v50
    v_and_b32 v52, 7, v51
    s_lshl_b32 s64, s19, 1
    v_xor_b32 v53, s64, v52
    v_lshlrev_b32 v54, 8, v51
    v_lshl_add_u32 v54, v53, 5, v54
    v_and_b32 v55, 3, v3
    v_lshl_add_u32 v54, v55, 3, v54
    v_add_u32 v54, 65536, v54
    v_xor_b32 v55, 32, v54
    v_mov_b32 v120, 0
    v_mov_b32 v121, 0
    v_mov_b32 v122, 0
    v_mov_b32 v123, 0
    v_mov_b32 v124, 0
    v_mov_b32 v125, 0
    v_mov_b32 v126, 0
    v_mov_b32 v127, 0
    s_waitcnt lgkmcnt(0)
    s_barrier
    ds_read2_b64 v[64:67], v49 offset0:0 offset1:4
    ds_read2_b64 v[68:71], v49 offset0:8 offset1:12
    ds_read2_b64 v[72:75], v49 offset0:16 offset1:20
    ds_read2_b64 v[76:79], v49 offset0:24 offset1:28
    ds_read_b64_tr_b16 v[80:81], v54 offset:0
    ds_read_b64_tr_b16 v[82:83], v54 offset:4096
    ds_read_b64_tr_b16 v[84:85], v55 offset:0
    ds_read_b64_tr_b16 v[86:87], v55 offset:4096
    ds_read_b64_tr_b16 v[88:89], v54 offset:8192
    ds_read_b64_tr_b16 v[90:91], v54 offset:12288
    ds_read_b64_tr_b16 v[92:93], v55 offset:8192
    ds_read_b64_tr_b16 v[94:95], v55 offset:12288
    ds_read_b64_tr_b16 v[96:97], v54 offset:16384
    ds_read_b64_tr_b16 v[98:99], v54 offset:20480
    ds_read_b64_tr_b16 v[100:101], v55 offset:16384
    ds_read_b64_tr_b16 v[102:103], v55 offset:20480
    ds_read_b64_tr_b16 v[104:105], v54 offset:24576
    ds_read_b64_tr_b16 v[106:107], v54 offset:28672
    ds_read_b64_tr_b16 v[108:109], v55 offset:24576
    ds_read_b64_tr_b16 v[110:111], v55 offset:28672
    s_waitcnt lgkmcnt(14)
    v_mfma_f32_16x16x32_bf16 v[120:123], v[64:67], v[80:83], v[120:123]
    s_waitcnt lgkmcnt(12)
    v_mfma_f32_16x16x32_bf16 v[124:127], v[64:67], v[84:87], v[124:127]
    s_waitcnt lgkmcnt(10)
    v_mfma_f32_16x16x32_bf16 v[120:123], v[68:71], v[88:91], v[120:123]
    s_waitcnt lgkmcnt(8)
    v_mfma_f32_16x16x32_bf16 v[124:127], v[68:71], v[92:95], v[124:127]
    s_waitcnt lgkmcnt(6)
    v_mfma_f32_16x16x32_bf16 v[120:123], v[72:75], v[96:99], v[120:123]
    s_waitcnt lgkmcnt(4)
    v_mfma_f32_16x16x32_bf16 v[124:127], v[72:75], v[100:103], v[124:127]
    s_waitcnt lgkmcnt(2)
    v_mfma_f32_16x16x32_bf16 v[120:123], v[76:79], v[104:107], v[120:123]
    s_waitcnt lgkmcnt(0)
    v_mfma_f32_16x16x32_bf16 v[124:127], v[76:79], v[108:111], v[124:127]
    v_mul_u32_u24 v56, 1088, v2
    v_lshl_add_u32 v56, v3, 1, v56
    s_lshl_b32 s64, s19, 6
    s_add_u32 s64, s64, 101504
    v_add_u32 v56, s64, v56
    s_nop 7
    v_cvt_pk_bf16_f32 v96, v120, v121
    v_cvt_pk_bf16_f32 v97, v122, v123
    v_cvt_pk_bf16_f32 v98, v124, v125
    v_cvt_pk_bf16_f32 v99, v126, v127
    ds_write_b16 v56, v96 offset:0
    ds_write_b16_d16_hi v56, v96 offset:272
    ds_write_b16 v56, v97 offset:544
    ds_write_b16_d16_hi v56, v97 offset:816
    ds_write_b16 v56, v98 offset:32
    ds_write_b16_d16_hi v56, v98 offset:304
    ds_write_b16 v56, v99 offset:576
    ds_write_b16_d16_hi v56, v99 offset:848
    s_waitcnt vmcnt(0) lgkmcnt(0)
    s_barrier
    s_branch K3_O
K3_B:
    buffer_load_dwordx2 v[144:145], v18, s[40:43], s64 offen
    v_lshlrev_b32 v10, 1, v2
    v_xor_b32 v10, v10, v3
    v_lshlrev_b32 v10, 4, v10
    v_lshl_add_u32 v10, v2, 13, v10
    v_xor_b32 v11, 0x80, v10
    s_lshl_b32 s64, s17, 7
    s_lshl_b32 s65, s19, 5
    s_add_u32 s64, s64, s65
    s_lshl_b32 s64, s64, 13
    s_lshl_b32 s66, s16, 8
    s_add_u32 s64, s64, s66
    s_lshl_b32 s65, s65, 8
    s_add_u32 s65, s65, 65536
    s_mov_b32 m0, s65
    s_nop 0
    buffer_load_dwordx4 v10, s[48:51], s64 offen lds
    s_add_u32 m0, m0, 1024
    s_add_u32 s64, s64, 32768
    buffer_load_dwordx4 v11, s[48:51], s64 offen lds
    s_add_u32 m0, m0, 1024
    s_add_u32 s64, s64, 32768
    buffer_load_dwordx4 v10, s[48:51], s64 offen lds
    s_add_u32 m0, m0, 1024
    s_add_u32 s64, s64, 32768
    buffer_load_dwordx4 v11, s[48:51], s64 offen lds
    s_add_u32 m0, m0, 1024
    s_add_u32 s64, s64, 32768
    buffer_load_dwordx4 v10, s[48:51], s64 offen lds
    s_add_u32 m0, m0, 1024
    s_add_u32 s64, s64, 32768
    buffer_load_dwordx4 v11, s[48:51], s64 offen lds
    s_add_u32 m0, m0, 1024
    s_add_u32 s64, s64, 32768
    buffer_load_dwordx4 v10, s[48:51], s64 offen lds
    s_add_u32 m0, m0, 1024
    s_add_u32 s64, s64, 32768
    buffer_load_dwordx4 v11, s[48:51], s64 offen lds
    v_lshrrev_b32 v12, 5, v1
    v_and_b32 v13, 31, v1
    v_lshlrev_b32 v14, 1, v12
    v_xor_b32 v13, v13, v14
    v_lshlrev_b32 v13, 4, v13
    v_lshl_add_u32 v13, v12, 10, v13
    v_xor_b32 v20, 0, v13
    v_xor_b32 v21, 64, v13
    v_xor_b32 v22, 128, v13
    v_xor_b32 v23, 192, v13
    s_lshl_b32 s64, s16, 17
    s_lshl_b32 s65, s19, 15
    s_add_u32 s64, s64, s65
    s_lshl_b32 s65, s20, 9
    s_add_u32 s64, s64, s65
    s_lshl_b32 s65, s19, 14
    s_mov_b32 m0, s65
    s_nop 0
    buffer_load_dwordx4 v20, s[52:55], s64 offen lds
    s_add_u32 m0, m0, 1024
    s_add_u32 s64, s64, 2048
    buffer_load_dwordx4 v21, s[52:55], s64 offen lds
    s_add_u32 m0, m0, 1024
    s_add_u32 s64, s64, 2048
    buffer_load_dwordx4 v22, s[52:55], s64 offen lds
    s_add_u32 m0, m0, 1024
    s_add_u32 s64, s64, 2048
    buffer_load_dwordx4 v23, s[52:55], s64 offen lds
    s_add_u32 m0, m0, 1024
    s_add_u32 s64, s64, 2048
    buffer_load_dwordx4 v20, s[52:55], s64 offen lds
    s_add_u32 m0, m0, 1024
    s_add_u32 s64, s64, 2048
    buffer_load_dwordx4 v21, s[52:55], s64 offen lds
    s_add_u32 m0, m0, 1024
    s_add_u32 s64, s64, 2048
    buffer_load_dwordx4 v22, s[52:55], s64 offen lds
    s_add_u32 m0, m0, 1024
    s_add_u32 s64, s64, 2048
    buffer_load_dwordx4 v23, s[52:55], s64 offen lds
    s_add_u32 m0, m0, 1024
    s_add_u32 s64, s64, 2048
    buffer_load_dwordx4 v20, s[52:55], s64 offen lds
    s_add_u32 m0, m0, 1024
    s_add_u32 s64, s64, 2048
    buffer_load_dwordx4 v21, s[52:55], s64 offen lds
    s_add_u32 m0, m0, 1024
    s_add_u32 s64, s64, 2048
    buffer_load_dwordx4 v22, s[52:55], s64 offen lds
    s_add_u32 m0, m0, 1024
    s_add_u32 s64, s64, 2048
    buffer_load_dwordx4 v23, s[52:55], s64 offen lds
    s_add_u32 m0, m0, 1024
    s_add_u32 s64, s64, 2048
    buffer_load_dwordx4 v20, s[52:55], s64 offen lds
    s_add_u32 m0, m0, 1024
    s_add_u32 s64, s64, 2048
    buffer_load_dwordx4 v21, s[52:55], s64 offen lds
    s_add_u32 m0, m0, 1024
    s_add_u32 s64, s64, 2048
    buffer_load_dwordx4 v22, s[52:55], s64 offen lds
    s_add_u32 m0, m0, 1024
    s_add_u32 s64, s64, 2048
    buffer_load_dwordx4 v23, s[52:55], s64 offen lds
    v_and_b32 v15, 31, v1
    v_lshlrev_b32 v15, 4, v15
    v_lshl_add_u32 v15, v12, 10, v15
    s_lshl_b32 s64, s21, 14
    s_lshl_b32 s65, s19, 12
    s_add_u32 s64, s64, s65
    s_lshl_b32 s65, s20, 9
    s_add_u32 s64, s64, s65
    buffer_load_dwordx4 v[128:131], v15, s[56:59], s64 offen offset:0
    buffer_load_dwordx4 v[132:135], v15, s[56:59], s64 offen offset:2048
    v_lshrrev_b32 v50, 2, v3
    v_lshl_add_u32 v51, v2, 2, v50
    v_and_b32 v52, 7, v51
    v_and_b32 v57, 31, v1
    v_xor_b32 v57, v57, v14
    s_and_b32 s64, s19, 1
    s_lshl_b32 s64, s64, 3
    v_xor_b32 v57, s64, v57
    v_lshlrev_b32 v57, 4, v57
    v_lshl_add_u32 v57, v12, 9, v57
    s_lshl_b32 s64, s19, 11
    s_add_u32 s64, s64, 65536
    v_add_u32 v57, s64, v57
    v_xor_b32 v58, 64, v57
    s_waitcnt vmcnt(18)
    s_barrier
    s_waitcnt vmcnt(0)
    s_barrier
    ds_write_b128 v57, v[128:131] offset:0
    ds_write_b128 v58, v[132:135] offset:1024
K3_O:
    v_mul_u32_u24 v49, 272, v48
    v_lshl_add_u32 v49, v2, 3, v49
    v_add_u32 v49, 101504, v49
    ds_read2_b64 v[64:67], v49 offset0:0 offset1:4
    ds_read2_b64 v[68:71], v49 offset0:8 offset1:12
    ds_read2_b64 v[72:75], v49 offset0:16 offset1:20
    ds_read2_b64 v[76:79], v49 offset0:24 offset1:28
    v_lshlrev_b32 v54, 9, v51
    v_lshl_add_u32 v54, v52, 5, v54
    v_and_b32 v55, 3, v3
    v_lshl_add_u32 v54, v55, 3, v54
    s_lshr_b32 s64, s18, 2
    s_lshl_b32 s64, s64, 8
    v_add_u32 v54, s64, v54
    s_and_b32 s64, s18, 3
    s_lshl_b32 s64, s64, 6
    v_xor_b32 v100, s64, v54
    v_xor_b32 v101, 32, v100
    v_mov_b32 v160, 0
    v_mov_b32 v161, 0
    v_mov_b32 v162, 0
    v_mov_b32 v163, 0
    v_mov_b32 v164, 0
    v_mov_b32 v165, 0
    v_mov_b32 v166, 0
    v_mov_b32 v167, 0
    ds_read_b64_tr_b16 v[192:193], v100 offset:0
    ds_read_b64_tr_b16 v[194:195], v100 offset:8192
    ds_read_b64_tr_b16 v[196:197], v101 offset:0
    ds_read_b64_tr_b16 v[198:199], v101 offset:8192
    ds_read_b64_tr_b16 v[200:201], v100 offset:16384
    ds_read_b64_tr_b16 v[202:203], v100 offset:24576
    ds_read_b64_tr_b16 v[204:205], v101 offset:16384
    ds_read_b64_tr_b16 v[206:207], v101 offset:24576
    ds_read_b64_tr_b16 v[208:209], v100 offset:32768
    ds_read_b64_tr_b16 v[210:211], v100 offset:40960
    ds_read_b64_tr_b16 v[212:213], v101 offset:32768
    ds_read_b64_tr_b16 v[214:215], v101 offset:40960
    ds_read_b64_tr_b16 v[216:217], v100 offset:49152
    ds_read_b64_tr_b16 v[218:219], v100 offset:57344
    ds_read_b64_tr_b16 v[220:221], v101 offset:49152
    ds_read_b64_tr_b16 v[222:223], v101 offset:57344
    s_waitcnt lgkmcnt(14)
    v_mfma_f32_16x16x32_bf16 v[160:163], v[64:67], v[192:195], v[160:163]
    s_waitcnt lgkmcnt(12)
    v_mfma_f32_16x16x32_bf16 v[164:167], v[64:67], v[196:199], v[164:167]
    s_waitcnt lgkmcnt(10)
    v_mfma_f32_16x16x32_bf16 v[160:163], v[68:71], v[200:203], v[160:163]
    s_waitcnt lgkmcnt(8)
    v_mfma_f32_16x16x32_bf16 v[164:167], v[68:71], v[204:207], v[164:167]
    s_waitcnt lgkmcnt(6)
    v_mfma_f32_16x16x32_bf16 v[160:163], v[72:75], v[208:211], v[160:163]
    s_waitcnt lgkmcnt(4)
    v_mfma_f32_16x16x32_bf16 v[164:167], v[72:75], v[212:215], v[164:167]
    s_waitcnt lgkmcnt(2)
    v_mfma_f32_16x16x32_bf16 v[160:163], v[76:79], v[216:219], v[160:163]
    s_waitcnt lgkmcnt(0)
    v_mfma_f32_16x16x32_bf16 v[164:167], v[76:79], v[220:223], v[164:167]
    s_cmp_ge_u32 s21, 86
    s_cbranch_scc1 K3_NOFFN2
    s_barrier
    v_add_u32 v100, 65536, v100
    v_add_u32 v101, 65536, v101
    ds_read_b64_tr_b16 v[192:193], v100
    ds_read_b64_tr_b16 v[194:195], v101
    s_waitcnt lgkmcnt(0)
    v_mfma_f32_16x16x16_bf16 v[160:163], v[144:145], v[192:193], v[160:163]
    v_mfma_f32_16x16x16_bf16 v[164:167], v[144:145], v[194:195], v[164:167]
K3_NOFFN2:
    v_lshlrev_b32 v60, 12, v2
    v_lshl_add_u32 v60, v3, 2, v60
    v_cmp_lt_u32 vcc, 1, v2
    v_mov_b32 v61, 0x7f000000
    s_lshl_b32 s64, s2, 13
    s_lshl_b32 s65, s18, 7
    v_cndmask_b32 v60, v60, v61, vcc
    s_add_u32 s64, s64, s65
    s_add_u32 s64, s64, 17825792
    s_nop 7
    buffer_store_dword v160, v60, s[40:43], s64 offen offset:0 sc1
    buffer_store_dword v161, v60, s[40:43], s64 offen offset:1024 sc1
    buffer_store_dword v162, v60, s[40:43], s64 offen offset:2048 sc1
    buffer_store_dword v163, v60, s[40:43], s64 offen offset:3072 sc1
    buffer_store_dword v164, v60, s[40:43], s64 offen offset:64 sc1
    buffer_store_dword v165, v60, s[40:43], s64 offen offset:1088 sc1
    buffer_store_dword v166, v60, s[40:43], s64 offen offset:2112 sc1
    buffer_store_dword v167, v60, s[40:43], s64 offen offset:3136 sc1
K3_END:
    s_endpgm
.globl k4_kernel
.p2align 8
.type k4_kernel,@function
k4_kernel:
    s_cmp_ge_u32 s2, 64
    s_cbranch_scc1 K4_END
    s_load_dwordx2 s[4:5], s[0:1], 0
    s_load_dwordx2 s[8:9], s[0:1], 80
    s_load_dwordx2 s[6:7], s[0:1], 96
    v_and_b32 v1, 15, v0
    v_lshrrev_b32 v2, 4, v0
    v_lshrrev_b32 v4, 6, v0
    v_lshlrev_b32 v3, 16, v2
    v_readfirstlane_b32 s18, v4
    v_lshl_add_u32 v3, v1, 4, v3
    s_lshr_b32 s16, s2, 3
    s_lshl_b32 s16, s16, 10
    s_and_b32 s19, s2, 3
    s_lshl_b32 s19, s19, 8
    s_add_u32 s16, s16, s19
    s_bfe_u32 s19, s2, 0x10002
    s_lshl_b32 s19, s19, 20
    s_add_u32 s16, s16, s19
    s_waitcnt lgkmcnt(0)
    s_mov_b32 s20, s4
    s_and_b32 s21, s5, 0xffff
    s_mov_b32 s22, 8192
    s_mov_b32 s23, 0x00020000
    s_mov_b32 s24, s8
    s_and_b32 s25, s9, 0xffff
    s_mov_b32 s26, 8192
    s_mov_b32 s27, 0x00020000
    s_mov_b32 s40, s6
    s_and_b32 s41, s7, 0xffff
    s_mov_b32 s42, 23068672
    s_mov_b32 s43, 0x00020000
    s_add_u32 s44, s16, 17825792
    buffer_load_dwordx4 v[8:11], v3, s[40:43], s44 offen
    s_add_u32 s44, s44, 8192
    buffer_load_dwordx4 v[12:15], v3, s[40:43], s44 offen
    s_add_u32 s44, s44, 8192
    buffer_load_dwordx4 v[16:19], v3, s[40:43], s44 offen
    s_add_u32 s44, s44, 8192
    buffer_load_dwordx4 v[20:23], v3, s[40:43], s44 offen
    s_add_u32 s44, s44, 8192
    buffer_load_dwordx4 v[24:27], v3, s[40:43], s44 offen
    s_add_u32 s44, s44, 8192
    buffer_load_dwordx4 v[28:31], v3, s[40:43], s44 offen
    s_add_u32 s44, s44, 8192
    buffer_load_dwordx4 v[32:35], v3, s[40:43], s44 offen
    s_add_u32 s44, s44, 8192
    buffer_load_dwordx4 v[36:39], v3, s[40:43], s44 offen
    v_lshlrev_b32 v4, 3, v1
    s_lshl_b32 s17, s2, 7
    buffer_load_dwordx2 v[72:73], v4, s[20:23], s17 offen
    s_waitcnt vmcnt(1)
    v_add_f32 v8, v8, v12
    v_add_f32 v9, v9, v13
    v_add_f32 v10, v10, v14
    v_add_f32 v11, v11, v15
    v_add_f32 v8, v8, v16
    v_add_f32 v9, v9, v17
    v_add_f32 v10, v10, v18
    v_add_f32 v11, v11, v19
    v_add_f32 v8, v8, v20
    v_add_f32 v9, v9, v21
    v_add_f32 v10, v10, v22
    v_add_f32 v11, v11, v23
    v_add_f32 v8, v8, v24
    v_add_f32 v9, v9, v25
    v_add_f32 v10, v10, v26
    v_add_f32 v11, v11, v27
    v_add_f32 v8, v8, v28
    v_add_f32 v9, v9, v29
    v_add_f32 v10, v10, v30
    v_add_f32 v11, v11, v31
    v_add_f32 v8, v8, v32
    v_add_f32 v9, v9, v33
    v_add_f32 v10, v10, v34
    v_add_f32 v11, v11, v35
    v_add_f32 v8, v8, v36
    v_add_f32 v9, v9, v37
    v_add_f32 v10, v10, v38
    v_add_f32 v11, v11, v39
    v_mov_b32 v12, v8
    v_mov_b32 v13, v9
    v_mov_b32 v14, v10
    v_mov_b32 v15, v11
    s_nop 1
    v_permlane16_swap_b32 v8, v12
    v_permlane16_swap_b32 v9, v13
    v_permlane16_swap_b32 v10, v14
    v_permlane16_swap_b32 v11, v15
    s_nop 1
    v_add_f32 v8, v8, v12
    v_add_f32 v9, v9, v13
    v_add_f32 v10, v10, v14
    v_add_f32 v11, v11, v15
    v_mov_b32 v12, v8
    v_mov_b32 v13, v9
    v_mov_b32 v14, v10
    v_mov_b32 v15, v11
    s_nop 1
    v_permlane32_swap_b32 v8, v12
    v_permlane32_swap_b32 v9, v13
    v_permlane32_swap_b32 v10, v14
    v_permlane32_swap_b32 v11, v15
    s_nop 1
    v_add_f32 v8, v8, v12
    v_add_f32 v9, v9, v13
    v_add_f32 v10, v10, v14
    v_add_f32 v11, v11, v15
    v_lshlrev_b32 v5, 4, v0
    ds_write_b128 v5, v[8:11]
    s_waitcnt lgkmcnt(0)
    s_barrier
    v_lshlrev_b32 v5, 4, v1
    ds_read_b128 v[16:19], v5 offset:0
    ds_read_b128 v[20:23], v5 offset:1024
    ds_read_b128 v[24:27], v5 offset:2048
    ds_read_b128 v[28:31], v5 offset:3072
    s_waitcnt vmcnt(0) lgkmcnt(0)
    v_add_f32 v16, v16, v20
    v_add_f32 v24, v24, v28
    v_add_f32 v16, v16, v24
    v_add_f32 v17, v17, v21
    v_add_f32 v25, v25, v29
    v_add_f32 v17, v17, v25
    v_add_f32 v18, v18, v22
    v_add_f32 v26, v26, v30
    v_add_f32 v18, v18, v26
    v_add_f32 v19, v19, v23
    v_add_f32 v27, v27, v31
    v_add_f32 v19, v19, v27
    v_lshlrev_b32 v20, 16, v72
    v_and_b32 v21, 0xffff0000, v72
    v_lshlrev_b32 v22, 16, v73
    v_and_b32 v23, 0xffff0000, v73
    v_add_f32 v16, v16, v20
    v_add_f32 v17, v17, v21
    v_add_f32 v18, v18, v22
    v_add_f32 v19, v19, v23
    v_cvt_pk_bf16_f32 v24, v16, v17
    v_cvt_pk_bf16_f32 v25, v18, v19
    v_cmp_lt_u32 vcc, 15, v0
    v_mov_b32 v6, 0x7f000000
    s_nop 1
    v_cndmask_b32 v4, v4, v6, vcc
    buffer_store_dwordx2 v[24:25], v4, s[24:27], s17 offen
K4_END:
    s_endpgm
KALL_END:
.section .rodata,"a"
.p2align 6
.amdhsa_kernel k1_kernel
  .amdhsa_next_free_vgpr 256
  .amdhsa_next_free_sgpr 102
  .amdhsa_accum_offset 256
  .amdhsa_group_segment_fixed_size 0
  .amdhsa_kernarg_size 104
  .amdhsa_user_sgpr_count 2
  .amdhsa_user_sgpr_kernarg_segment_ptr 1
  .amdhsa_system_sgpr_workgroup_id_x 1
.end_amdhsa_kernel
.p2align 6
.amdhsa_kernel k2_kernel
  .amdhsa_next_free_vgpr 256
  .amdhsa_next_free_sgpr 102
  .amdhsa_accum_offset 256
  .amdhsa_group_segment_fixed_size 0
  .amdhsa_kernarg_size 104
  .amdhsa_user_sgpr_count 2
  .amdhsa_user_sgpr_kernarg_segment_ptr 1
  .amdhsa_system_sgpr_workgroup_id_x 1
.end_amdhsa_kernel
.p2align 6
.amdhsa_kernel k3_kernel
  .amdhsa_next_free_vgpr 256
  .amdhsa_next_free_sgpr 102
  .amdhsa_accum_offset 256
  .amdhsa_group_segment_fixed_size 0
  .amdhsa_kernarg_size 104
  .amdhsa_user_sgpr_count 2
  .amdhsa_user_sgpr_kernarg_segment_ptr 1
  .amdhsa_system_sgpr_workgroup_id_x 1
.end_amdhsa_kernel
.p2align 6
.amdhsa_kernel k4_kernel
  .amdhsa_next_free_vgpr 80
  .amdhsa_next_free_sgpr 102
  .amdhsa_accum_offset 80
  .amdhsa_group_segment_fixed_size 0
  .amdhsa_kernarg_size 104
  .amdhsa_user_sgpr_count 2
  .amdhsa_user_sgpr_kernarg_segment_ptr 1
  .amdhsa_system_sgpr_workgroup_id_x 1
.end_amdhsa_kernel
```
